```python
import torch

def _softmax(x, axis=-1):
    return torch.softmax(x, dim=axis)
def _gelu(x):
    return torch.nn.functional.gelu(x, approximate="tanh")
def _silu(x):
    return torch.nn.functional.silu(x)
def _sigmoid(x):
    return torch.sigmoid(x)
def _layernorm(x, axis=-1, eps=1e-5):
    m = x.mean(dim=axis, keepdim=True)
    v = x.var(dim=axis, keepdim=True, unbiased=False)
    return (x - m) / torch.sqrt(v + eps)
def _scatter_add(tgt, idx, src, axis=0):
    return tgt.clone().index_add_(axis, idx, src)
def _segment_sum(src, seg, n):
    out = torch.zeros((n,) + src.shape[1:], dtype=src.dtype)
    return out.index_add_(0, seg, src)
def _pad(x, pw):
    flat = tuple(v for pair in reversed(pw) for v in pair)
    return torch.nn.functional.pad(x, flat)

kernel_name = 'standalone__mha_block_cached__near_ridge'

def setup_inputs():

    _w = (lambda a: (lambda t: t.to(torch.bfloat16) if t.is_floating_point() else t)(torch.as_tensor(a)))
    B, Sq, D = 8, 128, 512
    H, Sk, Dh = 32, 2048, 128
    return {
        "x": _w((lambda *s: torch.randn(*s, dtype=torch.bfloat16) * 0.8)(B, Sq, D)),
        "k_cache": _w((lambda *s: torch.randn(*s, dtype=torch.bfloat16) * 0.8)(B, H, Sk, Dh)),
        "v_cache": _w((lambda *s: torch.randn(*s, dtype=torch.bfloat16) * 0.05)(B, H, Sk, Dh)),
        "wq": _w((lambda *s: torch.randn(*s, dtype=torch.bfloat16) * 0.8)(D, H * Dh) * (D ** -0.5)),
        "wo": _w((lambda *s: torch.randn(*s, dtype=torch.bfloat16) * 0.05)(H * Dh, D) * ((H * Dh) ** -0.5)),
    }

def reference(x, k_cache, v_cache, wq, wo):
    B, Sq, D = x.shape
    H, Dh = 32, 128
    q = (lambda x, *d: x.permute(*d))((x @ wq).reshape(B, Sq, H, Dh), 0, 2, 1, 3)
    scores = torch.einsum("bhqd,bhkd->bhqk", q, k_cache) * (Dh ** -0.5)
    p = _softmax(scores, axis=-1)
    o = torch.einsum("bhqk,bhkd->bhqd", p, v_cache)
    return (lambda x, *d: x.permute(*d))(o, 0, 2, 1, 3).reshape(B, Sq, H * Dh) @ wo
```

```asm
; @launch grid=(256,1,1) block=(256,1,1) lds=163840
.amdgcn_target "amdgcn-amd-amdhsa--gfx950"
.text
.globl standalone__mha_block_cached__near_ridge_kernel
.p2align 8
.type standalone__mha_block_cached__near_ridge_kernel,@function
standalone__mha_block_cached__near_ridge_kernel:
    s_cmp_ge_u32 s2, 256
    s_cbranch_scc1 L_done
    s_load_dwordx16 s[4:19], s[0:1], 0
    v_lshrrev_b32 v20, 6, v0
    s_nop 0
    v_readfirstlane_b32 s42, v20
    s_xor_b32 s3, s2, 0x0
    s_and_b32 s40, s3, 1
    s_lshl_b32 s40, s40, 2
    s_bfe_u32 s47, s3, 0x20003
    s_add_u32 s40, s40, s47
    s_bfe_u32 s41, s3, 0x20001
    s_lshl_b32 s41, s41, 3
    s_lshr_b32 s47, s3, 5
    s_add_u32 s41, s41, s47
    s_lshl_b32 s49, s40, 1
    s_add_u32 s49, s49, s41
    s_and_b32 s47, s49, 6
    s_cmp_eq_u32 s47, 2
    s_cselect_b32 s47, 2, 0
    s_add_u32 s49, s49, s47
    s_mul_i32 s97, s2, 0
    s_lshr_b32 s47, s2, 5
    s_nop 0
    s_and_b32 s97, s97, 31
    s_lshl_b32 s97, s97, 14
    v_and_b32 v208, 63, v0
    v_lshrrev_b32 v209, 4, v208
    v_and_b32 v210, 15, v208
    v_lshrrev_b32 v211, 5, v208
    v_and_b32 v212, 31, v208
    v_lshrrev_b32 v215, 2, v210
    v_and_b32 v216, 3, v208
    v_and_b32 v217, 1, v209
    v_lshrrev_b32 v219, 3, v208
    v_and_b32 v220, 7, v208
    v_lshlrev_b32 v27, 4, v208
    s_lshl_b32 s47, s42, 4
    v_add_u32 v218, s47, v209
    s_lshl_b32 s46, s42, 12
    s_lshl_b32 s57, s42, 13
    s_add_u32 s57, s57, 0x20000
    v_lshlrev_b32 v213, 2, v209
    v_xor_b32 v213, v213, v210
    v_lshlrev_b32 v213, 4, v213
    v_lshl_add_u32 v197, v218, 13, v213
    v_lshl_add_u32 v17, v218, 8, v213
    s_lshl_b32 s47, s42, 5
    v_add_u32 v214, s47, v219
    v_lshrrev_b32 v213, 1, v219
    v_add_u32 v213, 0, v213
    v_xor_b32 v213, v213, v220
    v_lshlrev_b32 v213, 4, v213
    v_lshl_add_u32 v199, v214, 10, v213
    v_lshrrev_b32 v213, 1, v219
    v_add_u32 v213, 4, v213
    v_xor_b32 v213, v213, v220
    v_lshlrev_b32 v213, 4, v213
    v_lshl_add_u32 v200, v214, 10, v213
    s_waitcnt lgkmcnt(0)
    s_lshl_b32 s48, s40, 17
    s_add_u32 s28, s4, s48
    s_addc_u32 s29, s5, 0
    s_mov_b32 s30, 0x20000
    s_mov_b32 s31, 0x20000
    s_lshl_b32 s48, s41, 8
    s_add_u32 s32, s10, s48
    s_addc_u32 s33, s11, 0
    s_sub_u32 s34, 0x400000, s48
    s_mov_b32 s35, 0x20000
    s_add_u32 s76, s18, 0x1000000
    s_addc_u32 s77, s19, 0
    s_mov_b32 s78, 0x1000
    s_mov_b32 s79, 0x20000
    s_mov_b32 s80, s16
    s_mov_b32 s81, s17
    s_mov_b32 s82, 256
    s_mov_b32 s83, 0x20000
    v_mov_b32 v21, 1
    s_lshl_b32 s48, s40, 2
    s_add_u32 s48, s48, s42
    s_lshl_b32 s48, s48, 5
    s_add_u32 s48, s48, s41
    s_lshl_b32 s47, s48, 2
    v_mov_b32 v205, s47
    v_mov_b32 v213, 0
    s_mov_b64 exec, 1
    buffer_store_dword v213, v205, s[76:79], 0 offen offset:0 sc1
    s_mov_b64 exec, -1
    s_lshl_b32 s48, s48, 13
    s_add_u32 s36, s18, s48
    s_addc_u32 s37, s19, 0
    s_mov_b32 s38, 0x2000
    s_mov_b32 s39, 0x20000
    s_add_u32 s47, s49, 0
    s_and_b32 s47, s47, 7
    s_lshl_b32 s51, s47, 7
    s_add_u32 m0, s46, 49152
    s_lshl_b32 s50, s51, 12
    buffer_load_dwordx4 v197, s[32:35], s50 offen offset:0 lds
    s_add_u32 m0, s46, 50176
    s_add_u32 s50, s50, 0x8000
    buffer_load_dwordx4 v197, s[32:35], s50 offen offset:0 lds
    s_add_u32 m0, s46, 51200
    s_add_u32 s50, s50, 0x8000
    buffer_load_dwordx4 v197, s[32:35], s50 offen offset:0 lds
    s_add_u32 m0, s46, 52224
    s_add_u32 s50, s50, 0x8000
    buffer_load_dwordx4 v197, s[32:35], s50 offen offset:0 lds
    s_add_u32 m0, s46, 81920
    s_nop 0
    buffer_load_dwordx4 v199, s[28:31], s51 offen offset:0 lds
    s_add_u32 m0, s46, 82944
    s_add_u32 s51, s51, 0x2000
    buffer_load_dwordx4 v200, s[28:31], s51 offen offset:0 lds
    s_add_u32 m0, s46, 83968
    s_add_u32 s51, s51, 0x2000
    buffer_load_dwordx4 v199, s[28:31], s51 offen offset:0 lds
    s_add_u32 m0, s46, 84992
    s_add_u32 s51, s51, 0x2000
    buffer_load_dwordx4 v200, s[28:31], s51 offen offset:0 lds
    s_add_u32 s47, s49, 1
    s_and_b32 s47, s47, 7
    s_lshl_b32 s51, s47, 7
    s_add_u32 m0, s46, 98304
    s_lshl_b32 s50, s51, 12
    buffer_load_dwordx4 v197, s[32:35], s50 offen offset:0 lds
    s_add_u32 m0, s46, 99328
    s_add_u32 s50, s50, 0x8000
    buffer_load_dwordx4 v197, s[32:35], s50 offen offset:0 lds
    s_add_u32 m0, s46, 100352
    s_add_u32 s50, s50, 0x8000
    buffer_load_dwordx4 v197, s[32:35], s50 offen offset:0 lds
    s_add_u32 m0, s46, 101376
    s_add_u32 s50, s50, 0x8000
    buffer_load_dwordx4 v197, s[32:35], s50 offen offset:0 lds
    s_add_u32 m0, s46, 114688
    s_nop 0
    buffer_load_dwordx4 v199, s[28:31], s51 offen offset:0 lds
    s_add_u32 m0, s46, 115712
    s_add_u32 s51, s51, 0x2000
    buffer_load_dwordx4 v200, s[28:31], s51 offen offset:0 lds
    s_add_u32 m0, s46, 116736
    s_add_u32 s51, s51, 0x2000
    buffer_load_dwordx4 v199, s[28:31], s51 offen offset:0 lds
    s_add_u32 m0, s46, 117760
    s_add_u32 s51, s51, 0x2000
    buffer_load_dwordx4 v200, s[28:31], s51 offen offset:0 lds
    s_lshl_b32 s47, s2, 14
    s_add_u32 s92, s12, s47
    s_addc_u32 s93, s13, 0
    s_mov_b32 s94, 0x4000
    s_mov_b32 s95, 0x20000
    s_add_u32 m0, s46, 32768
    v_xor_b32 v48, 0, v27
    buffer_load_dwordx4 v48, s[92:95], s46 offen offset:0 lds
    v_xor_b32 v49, 64, v27
    buffer_load_dwordx4 v49, s[92:95], s46 offen offset:1024 lds
    v_xor_b32 v50, 128, v27
    buffer_load_dwordx4 v50, s[92:95], s46 offen offset:2048 lds
    v_xor_b32 v51, 192, v27
    buffer_load_dwordx4 v51, s[92:95], s46 offen offset:3072 lds
    s_lshl_b32 s47, s40, 5
    s_add_u32 s47, s47, s41
    s_lshl_b32 s48, s47, 19
    s_add_u32 s20, s6, s48
    s_addc_u32 s21, s7, 0
    s_mov_b32 s22, 0x80000
    s_mov_b32 s23, 0x20000
    s_add_u32 s24, s8, s48
    s_addc_u32 s25, s9, 0
    s_mov_b32 s26, 0x80000
    s_mov_b32 s27, 0x20000
    v_add_u32 v213, 0, v209
    v_xor_b32 v213, v213, v210
    v_lshlrev_b32 v213, 4, v213
    v_lshl_add_u32 v13, v218, 8, v213
    v_add_u32 v213, 4, v209
    v_xor_b32 v213, v213, v210
    v_lshlrev_b32 v213, 4, v213
    v_lshl_add_u32 v14, v218, 8, v213
    v_add_u32 v213, 8, v209
    v_xor_b32 v213, v213, v210
    v_lshlrev_b32 v213, 4, v213
    v_lshl_add_u32 v15, v218, 8, v213
    v_add_u32 v213, 12, v209
    v_xor_b32 v213, v213, v210
    v_lshlrev_b32 v213, 4, v213
    v_lshl_add_u32 v16, v218, 8, v213
    v_or_b32 v213, 0, v211
    v_xor_b32 v213, v213, v210
    v_lshlrev_b32 v213, 4, v213
    v_lshl_add_u32 v1, v212, 8, v213
    v_or_b32 v213, 2, v211
    v_xor_b32 v213, v213, v210
    v_lshlrev_b32 v213, 4, v213
    v_lshl_add_u32 v2, v212, 8, v213
    v_or_b32 v213, 4, v211
    v_xor_b32 v213, v213, v210
    v_lshlrev_b32 v213, 4, v213
    v_lshl_add_u32 v3, v212, 8, v213
    v_or_b32 v213, 6, v211
    v_xor_b32 v213, v213, v210
    v_lshlrev_b32 v213, 4, v213
    v_lshl_add_u32 v4, v212, 8, v213
    v_or_b32 v213, 8, v211
    v_xor_b32 v213, v213, v210
    v_lshlrev_b32 v213, 4, v213
    v_lshl_add_u32 v5, v212, 8, v213
    v_or_b32 v213, 10, v211
    v_xor_b32 v213, v213, v210
    v_lshlrev_b32 v213, 4, v213
    v_lshl_add_u32 v6, v212, 8, v213
    v_or_b32 v213, 12, v211
    v_xor_b32 v213, v213, v210
    v_lshlrev_b32 v213, 4, v213
    v_lshl_add_u32 v7, v212, 8, v213
    v_or_b32 v213, 14, v211
    v_xor_b32 v213, v213, v210
    v_lshlrev_b32 v213, 4, v213
    v_lshl_add_u32 v8, v212, 8, v213
    v_xor_b32 v213, 0, v215
    v_lshlrev_b32 v213, 1, v213
    v_add_u32 v213, v213, v217
    v_lshlrev_b32 v213, 1, v213
    v_lshrrev_b32 v214, 1, v216
    v_add_u32 v213, v213, v214
    v_lshlrev_b32 v213, 4, v213
    v_and_b32 v214, 1, v216
    v_lshl_add_u32 v213, v214, 3, v213
    v_lshl_add_u32 v214, v211, 2, v215
    v_lshl_add_u32 v213, v214, 8, v213
    v_add_u32 v9, 65536, v213
    v_xor_b32 v213, 0, v215
    v_lshlrev_b32 v213, 1, v213
    v_add_u32 v213, v213, v217
    v_lshlrev_b32 v213, 1, v213
    v_and_b32 v214, 1, v216
    v_add_u32 v213, v213, v214
    v_lshlrev_b32 v213, 4, v213
    v_lshrrev_b32 v214, 1, v216
    v_lshl_add_u32 v213, v214, 3, v213
    v_lshl_add_u32 v214, v211, 3, v215
    v_lshl_add_u32 v213, v214, 8, v213
    v_add_u32 v192, 0, v213
    v_xor_b32 v213, 1, v215
    v_lshlrev_b32 v213, 1, v213
    v_add_u32 v213, v213, v217
    v_lshlrev_b32 v213, 1, v213
    v_lshrrev_b32 v214, 1, v216
    v_add_u32 v213, v213, v214
    v_lshlrev_b32 v213, 4, v213
    v_and_b32 v214, 1, v216
    v_lshl_add_u32 v213, v214, 3, v213
    v_lshl_add_u32 v214, v211, 2, v215
    v_lshl_add_u32 v213, v214, 8, v213
    v_add_u32 v10, 65536, v213
    v_xor_b32 v213, 1, v215
    v_lshlrev_b32 v213, 1, v213
    v_add_u32 v213, v213, v217
    v_lshlrev_b32 v213, 1, v213
    v_and_b32 v214, 1, v216
    v_add_u32 v213, v213, v214
    v_lshlrev_b32 v213, 4, v213
    v_lshrrev_b32 v214, 1, v216
    v_lshl_add_u32 v213, v214, 3, v213
    v_lshl_add_u32 v214, v211, 3, v215
    v_lshl_add_u32 v213, v214, 8, v213
    v_add_u32 v193, 0, v213
    v_xor_b32 v213, 2, v215
    v_lshlrev_b32 v213, 1, v213
    v_add_u32 v213, v213, v217
    v_lshlrev_b32 v213, 1, v213
    v_lshrrev_b32 v214, 1, v216
    v_add_u32 v213, v213, v214
    v_lshlrev_b32 v213, 4, v213
    v_and_b32 v214, 1, v216
    v_lshl_add_u32 v213, v214, 3, v213
    v_lshl_add_u32 v214, v211, 2, v215
    v_lshl_add_u32 v213, v214, 8, v213
    v_add_u32 v11, 65536, v213
    v_xor_b32 v213, 2, v215
    v_lshlrev_b32 v213, 1, v213
    v_add_u32 v213, v213, v217
    v_lshlrev_b32 v213, 1, v213
    v_and_b32 v214, 1, v216
    v_add_u32 v213, v213, v214
    v_lshlrev_b32 v213, 4, v213
    v_lshrrev_b32 v214, 1, v216
    v_lshl_add_u32 v213, v214, 3, v213
    v_lshl_add_u32 v214, v211, 3, v215
    v_lshl_add_u32 v213, v214, 8, v213
    v_add_u32 v194, 0, v213
    v_xor_b32 v213, 3, v215
    v_lshlrev_b32 v213, 1, v213
    v_add_u32 v213, v213, v217
    v_lshlrev_b32 v213, 1, v213
    v_lshrrev_b32 v214, 1, v216
    v_add_u32 v213, v213, v214
    v_lshlrev_b32 v213, 4, v213
    v_and_b32 v214, 1, v216
    v_lshl_add_u32 v213, v214, 3, v213
    v_lshl_add_u32 v214, v211, 2, v215
    v_lshl_add_u32 v213, v214, 8, v213
    v_add_u32 v12, 65536, v213
    v_xor_b32 v213, 3, v215
    v_lshlrev_b32 v213, 1, v213
    v_add_u32 v213, v213, v217
    v_lshlrev_b32 v213, 1, v213
    v_and_b32 v214, 1, v216
    v_add_u32 v213, v213, v214
    v_lshlrev_b32 v213, 4, v213
    v_lshrrev_b32 v214, 1, v216
    v_lshl_add_u32 v213, v214, 3, v213
    v_lshl_add_u32 v214, v211, 3, v215
    v_lshl_add_u32 v213, v214, 8, v213
    v_add_u32 v195, 0, v213
    s_lshl_b32 s47, s42, 8
    s_add_u32 s47, s47, 0x8000
    v_xor_b32 v213, 0, v215
    v_lshlrev_b32 v213, 1, v213
    v_add_u32 v213, v213, v217
    v_lshlrev_b32 v213, 1, v213
    v_lshrrev_b32 v214, 1, v216
    v_add_u32 v213, v213, v214
    v_lshlrev_b32 v213, 4, v213
    v_and_b32 v214, 1, v216
    v_lshl_add_u32 v213, v214, 3, v213
    v_lshl_add_u32 v214, v211, 2, v215
    v_lshl_add_u32 v213, v214, 10, v213
    v_add_u32 v52, s47, v213
    v_xor_b32 v213, 1, v215
    v_lshlrev_b32 v213, 1, v213
    v_add_u32 v213, v213, v217
    v_lshlrev_b32 v213, 1, v213
    v_lshrrev_b32 v214, 1, v216
    v_add_u32 v213, v213, v214
    v_lshlrev_b32 v213, 4, v213
    v_and_b32 v214, 1, v216
    v_lshl_add_u32 v213, v214, 3, v213
    v_lshl_add_u32 v214, v211, 2, v215
    v_lshl_add_u32 v213, v214, 10, v213
    v_add_u32 v53, s47, v213
    v_xor_b32 v213, 2, v215
    v_lshlrev_b32 v213, 1, v213
    v_add_u32 v213, v213, v217
    v_lshlrev_b32 v213, 1, v213
    v_lshrrev_b32 v214, 1, v216
    v_add_u32 v213, v213, v214
    v_lshlrev_b32 v213, 4, v213
    v_and_b32 v214, 1, v216
    v_lshl_add_u32 v213, v214, 3, v213
    v_lshl_add_u32 v214, v211, 2, v215
    v_lshl_add_u32 v213, v214, 10, v213
    v_add_u32 v54, s47, v213
    v_xor_b32 v213, 3, v215
    v_lshlrev_b32 v213, 1, v213
    v_add_u32 v213, v213, v217
    v_lshlrev_b32 v213, 1, v213
    v_lshrrev_b32 v214, 1, v216
    v_add_u32 v213, v213, v214
    v_lshlrev_b32 v213, 4, v213
    v_and_b32 v214, 1, v216
    v_lshl_add_u32 v213, v214, 3, v213
    v_lshl_add_u32 v214, v211, 2, v215
    v_lshl_add_u32 v213, v214, 10, v213
    v_add_u32 v55, s47, v213
    v_add_u32 v24, s57, v27
    v_lshlrev_b32 v213, 6, v208
    v_add_u32 v0, s46, v213
    s_add_u32 s47, s46, 0x4000
    v_bfe_u32 v214, v212, 1, 3
    v_or_b32 v213, 0, v211
    v_xor_b32 v213, v213, v214
    v_lshlrev_b32 v213, 4, v213
    v_lshl_add_u32 v213, v212, 7, v213
    v_add_u32 v201, s47, v213
    v_bfe_u32 v214, v212, 1, 3
    v_or_b32 v213, 2, v211
    v_xor_b32 v213, v213, v214
    v_lshlrev_b32 v213, 4, v213
    v_lshl_add_u32 v213, v212, 7, v213
    v_add_u32 v202, s47, v213
    v_bfe_u32 v214, v212, 1, 3
    v_or_b32 v213, 4, v211
    v_xor_b32 v213, v213, v214
    v_lshlrev_b32 v213, 4, v213
    v_lshl_add_u32 v213, v212, 7, v213
    v_add_u32 v203, s47, v213
    v_bfe_u32 v214, v212, 1, 3
    v_or_b32 v213, 6, v211
    v_xor_b32 v213, v213, v214
    v_lshlrev_b32 v213, 4, v213
    v_lshl_add_u32 v213, v212, 7, v213
    v_add_u32 v204, s47, v213
    v_mov_b32 v28, v205
    s_xor_b32 s3, s2, 0x0
    s_and_b32 s48, s3, 7
    s_lshl_b32 s48, s48, 5
    s_lshr_b32 s47, s3, 3
    s_add_u32 s48, s48, s47
    s_bfe_u32 s52, s48, 0x20005
    s_lshl_b32 s52, s52, 3
    s_and_b32 s47, s48, 7
    s_add_u32 s52, s52, s47
    s_bfe_u32 s53, s48, 0x10007
    s_lshl_b32 s53, s53, 2
    s_bfe_u32 s47, s48, 0x20003
    s_add_u32 s53, s53, s47
    s_lshl_b32 s54, s47, 1
    s_add_u32 s47, s54, 0
    s_and_b32 s47, s47, 7
    s_lshl_b32 s84, s47, 14
    s_add_u32 s47, s54, 1
    s_and_b32 s47, s47, 7
    s_lshl_b32 s85, s47, 14
    s_add_u32 s47, s54, 2
    s_and_b32 s47, s47, 7
    s_lshl_b32 s86, s47, 14
    s_add_u32 s47, s54, 3
    s_and_b32 s47, s47, 7
    s_lshl_b32 s87, s47, 14
    s_add_u32 s47, s54, 4
    s_and_b32 s47, s47, 7
    s_lshl_b32 s88, s47, 14
    s_add_u32 s47, s54, 5
    s_and_b32 s47, s47, 7
    s_lshl_b32 s89, s47, 14
    s_add_u32 s47, s54, 6
    s_and_b32 s47, s47, 7
    s_lshl_b32 s90, s47, 14
    s_add_u32 s47, s54, 7
    s_and_b32 s47, s47, 7
    s_lshl_b32 s91, s47, 14
    s_lshl_b32 s47, s42, 17
    s_lshl_b32 s48, s53, 19
    s_add_u32 s47, s47, s48
    s_add_u32 s47, s47, 0x2000000
    s_add_u32 s64, s18, s47
    s_addc_u32 s65, s19, 0
    s_mov_b32 s66, 0x20000
    s_mov_b32 s67, 0x20000
    s_lshl_b32 s48, s53, 7
    s_lshl_b32 s47, s52, 15
    s_add_u32 s47, s47, s48
    s_add_u32 s72, s14, s47
    s_addc_u32 s73, s15, 0
    s_sub_u32 s74, 0x8000, s48
    s_mov_b32 s75, 0x20000
    s_lshl_b32 s47, s52, 18
    s_lshl_b32 s48, s42, 16
    s_add_u32 s47, s47, s48
    s_add_u32 s68, s18, s47
    s_addc_u32 s69, s19, 0
    s_mov_b32 s70, 0x10000
    s_mov_b32 s71, 0x20000
    v_lshrrev_b32 v29, 4, v27
    v_add_u32 v29, s54, v29
    v_and_b32 v29, 7, v29
    s_lshl_b32 s47, s52, 5
    s_lshl_b32 s48, s42, 3
    s_add_u32 s47, s47, s48
    v_add_u32 v29, s47, v29
    v_lshlrev_b32 v29, 2, v29
    v_add_u32 v176, 98304, v192
    v_add_u32 v180, 65536, v201
    v_add_u32 v177, 98304, v193
    v_add_u32 v181, 65536, v202
    v_add_u32 v178, 98304, v194
    v_add_u32 v182, 65536, v203
    v_add_u32 v179, 98304, v195
    v_add_u32 v183, 65536, v204
    s_waitcnt vmcnt(12)
    s_barrier
    ds_read_b128 v[224:227], v180 offset:0
    ds_read_b128 v[228:231], v181 offset:0
    ds_read_b128 v[232:235], v182 offset:0
    ds_read_b128 v[236:239], v183 offset:0
    ds_read_b64_tr_b16 v[128:129], v192 offset:49152
    ds_read_b64_tr_b16 v[130:131], v192 offset:50176
    ds_read_b64_tr_b16 v[132:133], v193 offset:49152
    ds_read_b64_tr_b16 v[134:135], v193 offset:50176
    ds_read_b64_tr_b16 v[136:137], v194 offset:49152
    ds_read_b64_tr_b16 v[138:139], v194 offset:50176
    ds_read_b64_tr_b16 v[140:141], v195 offset:49152
    ds_read_b64_tr_b16 v[142:143], v195 offset:50176
    ds_read_b64_tr_b16 v[144:145], v192 offset:53248
    ds_read_b64_tr_b16 v[146:147], v192 offset:54272
    ds_read_b64_tr_b16 v[148:149], v193 offset:53248
    ds_read_b64_tr_b16 v[150:151], v193 offset:54272
    ds_read_b64_tr_b16 v[152:153], v194 offset:53248
    ds_read_b64_tr_b16 v[154:155], v194 offset:54272
    ds_read_b64_tr_b16 v[156:157], v195 offset:53248
    ds_read_b64_tr_b16 v[158:159], v195 offset:54272
    s_lshl_b32 s47, s42, 20
    s_lshl_b32 s48, s2, 11
    s_add_u32 s47, s47, s48
    s_add_u32 s47, s47, 0x2000000
    s_add_u32 s92, s18, s47
    s_addc_u32 s93, s19, 0
    s_mov_b32 s94, 0x80800
    s_mov_b32 s58, 0x80000
    s_waitcnt lgkmcnt(14)
    v_mfma_f32_32x32x16_bf16 v[64:79], v[128:131], v[224:227], 0
    ds_read_b64_tr_b16 v[160:161], v192 offset:57344
    ds_read_b64_tr_b16 v[162:163], v192 offset:58368
    s_add_u32 s47, s49, 2
    s_and_b32 s47, s47, 7
    s_lshl_b32 s51, s47, 7
    s_add_u32 m0, s46, 147456
    s_lshl_b32 s50, s51, 12
    buffer_load_dwordx4 v197, s[32:35], s50 offen offset:0 lds
    s_waitcnt lgkmcnt(14)
    v_mfma_f32_32x32x16_bf16 v[80:95], v[132:135], v[224:227], 0
    ds_read_b64_tr_b16 v[164:165], v193 offset:57344
    ds_read_b64_tr_b16 v[166:167], v193 offset:58368
    s_add_u32 m0, s46, 148480
    s_add_u32 s50, s50, 0x8000
    buffer_load_dwordx4 v197, s[32:35], s50 offen offset:0 lds
    s_add_u32 m0, s46, 149504
    s_add_u32 s50, s50, 0x8000
    buffer_load_dwordx4 v197, s[32:35], s50 offen offset:0 lds
    s_waitcnt lgkmcnt(14)
    v_mfma_f32_32x32x16_bf16 v[96:111], v[136:139], v[224:227], 0
    ds_read_b64_tr_b16 v[168:169], v194 offset:57344
    ds_read_b64_tr_b16 v[170:171], v194 offset:58368
    s_add_u32 m0, s46, 150528
    s_add_u32 s50, s50, 0x8000
    buffer_load_dwordx4 v197, s[32:35], s50 offen offset:0 lds
    s_waitcnt lgkmcnt(14)
    v_mfma_f32_32x32x16_bf16 v[112:127], v[140:143], v[224:227], 0
    ds_read_b64_tr_b16 v[172:173], v195 offset:57344
    ds_read_b64_tr_b16 v[174:175], v195 offset:58368
    s_add_u32 m0, s46, 131072
    s_nop 0
    buffer_load_dwordx4 v199, s[28:31], s51 offen offset:0 lds
    s_waitcnt lgkmcnt(14)
    v_mfma_f32_32x32x16_bf16 v[64:79], v[144:147], v[228:231], v[64:79]
    ds_read_b64_tr_b16 v[128:129], v192 offset:61440
    ds_read_b64_tr_b16 v[130:131], v192 offset:62464
    s_add_u32 m0, s46, 132096
    s_add_u32 s51, s51, 0x2000
    buffer_load_dwordx4 v200, s[28:31], s51 offen offset:0 lds
    s_add_u32 m0, s46, 133120
    s_add_u32 s51, s51, 0x2000
    buffer_load_dwordx4 v199, s[28:31], s51 offen offset:0 lds
    s_waitcnt lgkmcnt(14)
    v_mfma_f32_32x32x16_bf16 v[80:95], v[148:151], v[228:231], v[80:95]
    ds_read_b64_tr_b16 v[132:133], v193 offset:61440
    ds_read_b64_tr_b16 v[134:135], v193 offset:62464
    s_add_u32 m0, s46, 134144
    s_add_u32 s51, s51, 0x2000
    buffer_load_dwordx4 v200, s[28:31], s51 offen offset:0 lds
    s_waitcnt lgkmcnt(14)
    v_mfma_f32_32x32x16_bf16 v[96:111], v[152:155], v[228:231], v[96:111]
    ds_read_b64_tr_b16 v[136:137], v194 offset:61440
    ds_read_b64_tr_b16 v[138:139], v194 offset:62464
    s_add_u32 s47, s49, 3
    s_and_b32 s47, s47, 7
    s_lshl_b32 s51, s47, 7
    s_add_u32 m0, s46, 0
    s_lshl_b32 s50, s51, 12
    buffer_load_dwordx4 v197, s[32:35], s50 offen offset:0 lds
    s_waitcnt lgkmcnt(14)
    v_mfma_f32_32x32x16_bf16 v[112:127], v[156:159], v[228:231], v[112:127]
    ds_read_b64_tr_b16 v[140:141], v195 offset:61440
    ds_read_b64_tr_b16 v[142:143], v195 offset:62464
    s_add_u32 m0, s46, 1024
    s_add_u32 s50, s50, 0x8000
    buffer_load_dwordx4 v197, s[32:35], s50 offen offset:0 lds
    s_add_u32 m0, s46, 2048
    s_add_u32 s50, s50, 0x8000
    buffer_load_dwordx4 v197, s[32:35], s50 offen offset:0 lds
    s_waitcnt lgkmcnt(14)
    v_mfma_f32_32x32x16_bf16 v[64:79], v[160:163], v[232:235], v[64:79]
    s_add_u32 m0, s46, 3072
    s_add_u32 s50, s50, 0x8000
    buffer_load_dwordx4 v197, s[32:35], s50 offen offset:0 lds
    s_waitcnt lgkmcnt(12)
    v_mfma_f32_32x32x16_bf16 v[80:95], v[164:167], v[232:235], v[80:95]
    s_add_u32 m0, s46, 16384
    s_nop 0
    buffer_load_dwordx4 v199, s[28:31], s51 offen offset:0 lds
    s_waitcnt lgkmcnt(10)
    v_mfma_f32_32x32x16_bf16 v[96:111], v[168:171], v[232:235], v[96:111]
    s_add_u32 m0, s46, 17408
    s_add_u32 s51, s51, 0x2000
    buffer_load_dwordx4 v200, s[28:31], s51 offen offset:0 lds
    s_add_u32 m0, s46, 18432
    s_add_u32 s51, s51, 0x2000
    buffer_load_dwordx4 v199, s[28:31], s51 offen offset:0 lds
    s_waitcnt lgkmcnt(8)
    v_mfma_f32_32x32x16_bf16 v[112:127], v[172:175], v[232:235], v[112:127]
    s_add_u32 m0, s46, 19456
    s_add_u32 s51, s51, 0x2000
    buffer_load_dwordx4 v200, s[28:31], s51 offen offset:0 lds
    s_waitcnt vmcnt(16)
    s_waitcnt lgkmcnt(0)
    s_barrier
    ds_read_b128 v[240:243], v180 offset:32768
    ds_read_b128 v[244:247], v181 offset:32768
    ds_read_b128 v[248:251], v182 offset:32768
    ds_read_b128 v[252:255], v183 offset:32768
    ds_read_b64_tr_b16 v[144:145], v176 offset:0
    ds_read_b64_tr_b16 v[146:147], v176 offset:1024
    ds_read_b64_tr_b16 v[148:149], v177 offset:0
    ds_read_b64_tr_b16 v[150:151], v177 offset:1024
    ds_read_b64_tr_b16 v[152:153], v178 offset:0
    ds_read_b64_tr_b16 v[154:155], v178 offset:1024
    ds_read_b64_tr_b16 v[156:157], v179 offset:0
    ds_read_b64_tr_b16 v[158:159], v179 offset:1024
    ds_read_b64_tr_b16 v[160:161], v176 offset:4096
    ds_read_b64_tr_b16 v[162:163], v176 offset:5120
    ds_read_b64_tr_b16 v[164:165], v177 offset:4096
    ds_read_b64_tr_b16 v[166:167], v177 offset:5120
    ds_read_b64_tr_b16 v[168:169], v178 offset:4096
    ds_read_b64_tr_b16 v[170:171], v178 offset:5120
    ds_read_b64_tr_b16 v[172:173], v179 offset:4096
    ds_read_b64_tr_b16 v[174:175], v179 offset:5120
    ds_read_b64_tr_b16 v[32:33], v52 offset:0
    ds_read_b64_tr_b16 v[34:35], v52 offset:8192
    ds_read_b64_tr_b16 v[36:37], v53 offset:0
    ds_read_b64_tr_b16 v[38:39], v53 offset:8192
    ds_read_b64_tr_b16 v[40:41], v54 offset:0
    ds_read_b64_tr_b16 v[42:43], v54 offset:8192
    ds_read_b64_tr_b16 v[44:45], v55 offset:0
    ds_read_b64_tr_b16 v[46:47], v55 offset:8192
    v_mfma_f32_32x32x16_bf16 v[64:79], v[128:131], v[236:239], v[64:79]
    v_mfma_f32_32x32x16_bf16 v[80:95], v[132:135], v[236:239], v[80:95]
    v_mfma_f32_32x32x16_bf16 v[96:111], v[136:139], v[236:239], v[96:111]
    v_mfma_f32_32x32x16_bf16 v[112:127], v[140:143], v[236:239], v[112:127]
    s_waitcnt lgkmcnt(15)
    v_mfma_f32_32x32x16_bf16 v[64:79], v[144:147], v[240:243], v[64:79]
    ds_read_b64_tr_b16 v[128:129], v176 offset:8192
    ds_read_b64_tr_b16 v[130:131], v176 offset:9216
    s_add_u32 s47, s49, 5
    s_and_b32 s47, s47, 7
    s_lshl_b32 s51, s47, 7
    s_add_u32 m0, s46, 49152
    s_lshl_b32 s50, s51, 12
    buffer_load_dwordx4 v197, s[32:35], s50 offen offset:0 lds
    v_mfma_f32_32x32x16_bf16 v[80:95], v[148:151], v[240:243], v[80:95]
    ds_read_b64_tr_b16 v[132:133], v177 offset:8192
    ds_read_b64_tr_b16 v[134:135], v177 offset:9216
    s_add_u32 m0, s46, 50176
    s_add_u32 s50, s50, 0x8000
    buffer_load_dwordx4 v197, s[32:35], s50 offen offset:0 lds
    v_mfma_f32_32x32x16_bf16 v[96:111], v[152:155], v[240:243], v[96:111]
    ds_read_b64_tr_b16 v[136:137], v178 offset:8192
    ds_read_b64_tr_b16 v[138:139], v178 offset:9216
    s_add_u32 m0, s46, 51200
    s_add_u32 s50, s50, 0x8000
    buffer_load_dwordx4 v197, s[32:35], s50 offen offset:0 lds
    v_mfma_f32_32x32x16_bf16 v[112:127], v[156:159], v[240:243], v[112:127]
    ds_read_b64_tr_b16 v[140:141], v179 offset:8192
    ds_read_b64_tr_b16 v[142:143], v179 offset:9216
    s_add_u32 m0, s46, 52224
    s_add_u32 s50, s50, 0x8000
    buffer_load_dwordx4 v197, s[32:35], s50 offen offset:0 lds
    s_waitcnt lgkmcnt(15)
    v_mfma_f32_32x32x16_bf16 v[64:79], v[160:163], v[244:247], v[64:79]
    ds_read_b64_tr_b16 v[144:145], v176 offset:12288
    ds_read_b64_tr_b16 v[146:147], v176 offset:13312
    s_waitcnt lgkmcnt(15)
    buffer_store_dwordx4 v[32:35], v27, s[92:95], 0 offen offset:0 sc1
    v_mfma_f32_32x32x16_bf16 v[80:95], v[164:167], v[244:247], v[80:95]
    ds_read_b64_tr_b16 v[148:149], v177 offset:12288
    ds_read_b64_tr_b16 v[150:151], v177 offset:13312
    s_waitcnt lgkmcnt(15)
    buffer_store_dwordx4 v[36:39], v27, s[92:95], 0 offen offset:1024 sc1
    v_mfma_f32_32x32x16_bf16 v[96:111], v[168:171], v[244:247], v[96:111]
    ds_read_b64_tr_b16 v[152:153], v178 offset:12288
    ds_read_b64_tr_b16 v[154:155], v178 offset:13312
    s_waitcnt lgkmcnt(15)
    buffer_store_dwordx4 v[40:43], v27, s[92:95], s58 offen offset:0 sc1
    v_mfma_f32_32x32x16_bf16 v[112:127], v[172:175], v[244:247], v[112:127]
    ds_read_b64_tr_b16 v[156:157], v179 offset:12288
    ds_read_b64_tr_b16 v[158:159], v179 offset:13312
    s_waitcnt lgkmcnt(15)
    buffer_store_dwordx4 v[44:47], v27, s[92:95], s58 offen offset:1024 sc1
    s_waitcnt lgkmcnt(14)
    v_mfma_f32_32x32x16_bf16 v[64:79], v[128:131], v[248:251], v[64:79]
    s_add_u32 m0, s46, 81920
    s_nop 0
    buffer_load_dwordx4 v199, s[28:31], s51 offen offset:0 lds
    s_waitcnt lgkmcnt(12)
    v_mfma_f32_32x32x16_bf16 v[80:95], v[132:135], v[248:251], v[80:95]
    s_add_u32 m0, s46, 82944
    s_add_u32 s51, s51, 0x2000
    buffer_load_dwordx4 v200, s[28:31], s51 offen offset:0 lds
    s_waitcnt lgkmcnt(10)
    v_mfma_f32_32x32x16_bf16 v[96:111], v[136:139], v[248:251], v[96:111]
    s_add_u32 m0, s46, 83968
    s_add_u32 s51, s51, 0x2000
    buffer_load_dwordx4 v199, s[28:31], s51 offen offset:0 lds
    s_waitcnt lgkmcnt(8)
    v_mfma_f32_32x32x16_bf16 v[112:127], v[140:143], v[248:251], v[112:127]
    s_add_u32 m0, s46, 84992
    s_add_u32 s51, s51, 0x2000
    buffer_load_dwordx4 v200, s[28:31], s51 offen offset:0 lds
    s_waitcnt vmcnt(4)
    s_waitcnt lgkmcnt(0)
    s_barrier
    ds_read_b128 v[224:227], v180 offset:49152
    ds_read_b128 v[228:231], v181 offset:49152
    ds_read_b128 v[232:235], v182 offset:49152
    ds_read_b128 v[236:239], v183 offset:49152
    ds_read_b64_tr_b16 v[160:161], v176 offset:49152
    ds_read_b64_tr_b16 v[162:163], v176 offset:50176
    ds_read_b64_tr_b16 v[164:165], v177 offset:49152
    ds_read_b64_tr_b16 v[166:167], v177 offset:50176
    ds_read_b64_tr_b16 v[168:169], v178 offset:49152
    ds_read_b64_tr_b16 v[170:171], v178 offset:50176
    ds_read_b64_tr_b16 v[172:173], v179 offset:49152
    ds_read_b64_tr_b16 v[174:175], v179 offset:50176
    ds_read_b64_tr_b16 v[128:129], v176 offset:53248
    ds_read_b64_tr_b16 v[130:131], v176 offset:54272
    ds_read_b64_tr_b16 v[132:133], v177 offset:53248
    ds_read_b64_tr_b16 v[134:135], v177 offset:54272
    ds_read_b64_tr_b16 v[136:137], v178 offset:53248
    ds_read_b64_tr_b16 v[138:139], v178 offset:54272
    ds_read_b64_tr_b16 v[140:141], v179 offset:53248
    ds_read_b64_tr_b16 v[142:143], v179 offset:54272
    s_cmp_lg_u32 s42, 0
    s_cbranch_scc1 L_noclaim
    v_mov_b32 v20, 0
    s_mov_b64 exec, 1
    buffer_atomic_add v21, v20, s[80:83], 0 offen sc1
    s_mov_b64 exec, -1
L_noclaim:
    v_mfma_f32_32x32x16_bf16 v[64:79], v[144:147], v[252:255], v[64:79]
    v_mfma_f32_32x32x16_bf16 v[80:95], v[148:151], v[252:255], v[80:95]
    v_mfma_f32_32x32x16_bf16 v[96:111], v[152:155], v[252:255], v[96:111]
    v_mfma_f32_32x32x16_bf16 v[112:127], v[156:159], v[252:255], v[112:127]
    s_waitcnt lgkmcnt(14)
    v_mfma_f32_32x32x16_bf16 v[64:79], v[160:163], v[224:227], v[64:79]
    ds_read_b64_tr_b16 v[144:145], v176 offset:57344
    ds_read_b64_tr_b16 v[146:147], v176 offset:58368
    s_add_u32 s47, s49, 4
    s_and_b32 s47, s47, 7
    s_lshl_b32 s51, s47, 7
    s_add_u32 m0, s46, 32768
    s_lshl_b32 s50, s51, 12
    buffer_load_dwordx4 v197, s[32:35], s50 offen offset:0 lds
    s_waitcnt lgkmcnt(14)
    v_mfma_f32_32x32x16_bf16 v[80:95], v[164:167], v[224:227], v[80:95]
    ds_read_b64_tr_b16 v[148:149], v177 offset:57344
    ds_read_b64_tr_b16 v[150:151], v177 offset:58368
    s_add_u32 m0, s46, 33792
    s_add_u32 s50, s50, 0x8000
    buffer_load_dwordx4 v197, s[32:35], s50 offen offset:0 lds
    s_add_u32 m0, s46, 34816
    s_add_u32 s50, s50, 0x8000
    buffer_load_dwordx4 v197, s[32:35], s50 offen offset:0 lds
    s_waitcnt lgkmcnt(14)
    v_mfma_f32_32x32x16_bf16 v[96:111], v[168:171], v[224:227], v[96:111]
    ds_read_b64_tr_b16 v[152:153], v178 offset:57344
    ds_read_b64_tr_b16 v[154:155], v178 offset:58368
    s_add_u32 m0, s46, 35840
    s_add_u32 s50, s50, 0x8000
    buffer_load_dwordx4 v197, s[32:35], s50 offen offset:0 lds
    s_waitcnt lgkmcnt(14)
    v_mfma_f32_32x32x16_bf16 v[112:127], v[172:175], v[224:227], v[112:127]
    ds_read_b64_tr_b16 v[156:157], v179 offset:57344
    ds_read_b64_tr_b16 v[158:159], v179 offset:58368
    s_add_u32 m0, s46, 65536
    s_nop 0
    buffer_load_dwordx4 v199, s[28:31], s51 offen offset:0 lds
    s_waitcnt lgkmcnt(14)
    v_mfma_f32_32x32x16_bf16 v[64:79], v[128:131], v[228:231], v[64:79]
    ds_read_b64_tr_b16 v[160:161], v176 offset:61440
    ds_read_b64_tr_b16 v[162:163], v176 offset:62464
    s_add_u32 m0, s46, 66560
    s_add_u32 s51, s51, 0x2000
    buffer_load_dwordx4 v200, s[28:31], s51 offen offset:0 lds
    s_add_u32 m0, s46, 67584
    s_add_u32 s51, s51, 0x2000
    buffer_load_dwordx4 v199, s[28:31], s51 offen offset:0 lds
    s_waitcnt lgkmcnt(14)
    v_mfma_f32_32x32x16_bf16 v[80:95], v[132:135], v[228:231], v[80:95]
    ds_read_b64_tr_b16 v[164:165], v177 offset:61440
    ds_read_b64_tr_b16 v[166:167], v177 offset:62464
    s_add_u32 m0, s46, 68608
    s_add_u32 s51, s51, 0x2000
    buffer_load_dwordx4 v200, s[28:31], s51 offen offset:0 lds
    s_waitcnt lgkmcnt(14)
    v_mfma_f32_32x32x16_bf16 v[96:111], v[136:139], v[228:231], v[96:111]
    ds_read_b64_tr_b16 v[168:169], v178 offset:61440
    ds_read_b64_tr_b16 v[170:171], v178 offset:62464
    s_add_u32 s47, s49, 6
    s_and_b32 s47, s47, 7
    s_lshl_b32 s51, s47, 7
    s_add_u32 m0, s46, 98304
    s_lshl_b32 s50, s51, 12
    buffer_load_dwordx4 v197, s[32:35], s50 offen offset:0 lds
    s_waitcnt lgkmcnt(14)
    v_mfma_f32_32x32x16_bf16 v[112:127], v[140:143], v[228:231], v[112:127]
    ds_read_b64_tr_b16 v[172:173], v179 offset:61440
    ds_read_b64_tr_b16 v[174:175], v179 offset:62464
    s_add_u32 m0, s46, 99328
    s_add_u32 s50, s50, 0x8000
    buffer_load_dwordx4 v197, s[32:35], s50 offen offset:0 lds
    s_add_u32 m0, s46, 100352
    s_add_u32 s50, s50, 0x8000
    buffer_load_dwordx4 v197, s[32:35], s50 offen offset:0 lds
    s_waitcnt lgkmcnt(14)
    v_mfma_f32_32x32x16_bf16 v[64:79], v[144:147], v[232:235], v[64:79]
    s_add_u32 m0, s46, 101376
    s_add_u32 s50, s50, 0x8000
    buffer_load_dwordx4 v197, s[32:35], s50 offen offset:0 lds
    s_waitcnt lgkmcnt(12)
    v_mfma_f32_32x32x16_bf16 v[80:95], v[148:151], v[232:235], v[80:95]
    s_add_u32 m0, s46, 114688
    s_nop 0
    buffer_load_dwordx4 v199, s[28:31], s51 offen offset:0 lds
    s_waitcnt lgkmcnt(10)
    v_mfma_f32_32x32x16_bf16 v[96:111], v[152:155], v[232:235], v[96:111]
    s_add_u32 m0, s46, 115712
    s_add_u32 s51, s51, 0x2000
    buffer_load_dwordx4 v200, s[28:31], s51 offen offset:0 lds
    s_add_u32 m0, s46, 116736
    s_add_u32 s51, s51, 0x2000
    buffer_load_dwordx4 v199, s[28:31], s51 offen offset:0 lds
    s_waitcnt lgkmcnt(8)
    v_mfma_f32_32x32x16_bf16 v[112:127], v[156:159], v[232:235], v[112:127]
    s_add_u32 m0, s46, 117760
    s_add_u32 s51, s51, 0x2000
    buffer_load_dwordx4 v200, s[28:31], s51 offen offset:0 lds
    s_waitcnt vmcnt(63)
    s_waitcnt lgkmcnt(0)
    s_barrier
    ds_read_b128 v[240:243], v201 offset:0
    ds_read_b128 v[244:247], v202 offset:0
    ds_read_b128 v[248:251], v203 offset:0
    ds_read_b128 v[252:255], v204 offset:0
    ds_read_b64_tr_b16 v[128:129], v192 offset:0
    ds_read_b64_tr_b16 v[130:131], v192 offset:1024
    ds_read_b64_tr_b16 v[132:133], v193 offset:0
    ds_read_b64_tr_b16 v[134:135], v193 offset:1024
    ds_read_b64_tr_b16 v[136:137], v194 offset:0
    ds_read_b64_tr_b16 v[138:139], v194 offset:1024
    ds_read_b64_tr_b16 v[140:141], v195 offset:0
    ds_read_b64_tr_b16 v[142:143], v195 offset:1024
    ds_read_b64_tr_b16 v[144:145], v192 offset:4096
    ds_read_b64_tr_b16 v[146:147], v192 offset:5120
    ds_read_b64_tr_b16 v[148:149], v193 offset:4096
    ds_read_b64_tr_b16 v[150:151], v193 offset:5120
    ds_read_b64_tr_b16 v[152:153], v194 offset:4096
    ds_read_b64_tr_b16 v[154:155], v194 offset:5120
    ds_read_b64_tr_b16 v[156:157], v195 offset:4096
    ds_read_b64_tr_b16 v[158:159], v195 offset:5120
    v_mfma_f32_32x32x16_bf16 v[64:79], v[160:163], v[236:239], v[64:79]
    v_mfma_f32_32x32x16_bf16 v[80:95], v[164:167], v[236:239], v[80:95]
    v_mfma_f32_32x32x16_bf16 v[96:111], v[168:171], v[236:239], v[96:111]
    v_mfma_f32_32x32x16_bf16 v[112:127], v[172:175], v[236:239], v[112:127]
    s_waitcnt lgkmcnt(14)
    v_mfma_f32_32x32x16_bf16 v[64:79], v[128:131], v[240:243], v[64:79]
    ds_read_b64_tr_b16 v[160:161], v192 offset:8192
    ds_read_b64_tr_b16 v[162:163], v192 offset:9216
    s_add_u32 s47, s49, 7
    s_and_b32 s47, s47, 7
    s_lshl_b32 s51, s47, 7
    s_add_u32 m0, s46, 147456
    s_lshl_b32 s50, s51, 12
    buffer_load_dwordx4 v197, s[32:35], s50 offen offset:0 lds
    s_waitcnt lgkmcnt(14)
    v_mfma_f32_32x32x16_bf16 v[80:95], v[132:135], v[240:243], v[80:95]
    ds_read_b64_tr_b16 v[164:165], v193 offset:8192
    ds_read_b64_tr_b16 v[166:167], v193 offset:9216
    s_waitcnt lgkmcnt(14)
    v_mfma_f32_32x32x16_bf16 v[96:111], v[136:139], v[240:243], v[96:111]
    ds_read_b64_tr_b16 v[168:169], v194 offset:8192
    ds_read_b64_tr_b16 v[170:171], v194 offset:9216
    s_add_u32 m0, s46, 148480
    s_add_u32 s50, s50, 0x8000
    buffer_load_dwordx4 v197, s[32:35], s50 offen offset:0 lds
    s_waitcnt lgkmcnt(14)
    v_mfma_f32_32x32x16_bf16 v[112:127], v[140:143], v[240:243], v[112:127]
    ds_read_b64_tr_b16 v[172:173], v195 offset:8192
    ds_read_b64_tr_b16 v[174:175], v195 offset:9216
    s_add_u32 m0, s46, 149504
    s_add_u32 s50, s50, 0x8000
    buffer_load_dwordx4 v197, s[32:35], s50 offen offset:0 lds
    s_waitcnt lgkmcnt(14)
    v_mfma_f32_32x32x16_bf16 v[64:79], v[144:147], v[244:247], v[64:79]
    ds_read_b64_tr_b16 v[128:129], v192 offset:12288
    ds_read_b64_tr_b16 v[130:131], v192 offset:13312
    s_waitcnt lgkmcnt(14)
    v_mfma_f32_32x32x16_bf16 v[80:95], v[148:151], v[244:247], v[80:95]
    ds_read_b64_tr_b16 v[132:133], v193 offset:12288
    ds_read_b64_tr_b16 v[134:135], v193 offset:13312
    s_add_u32 m0, s46, 150528
    s_add_u32 s50, s50, 0x8000
    buffer_load_dwordx4 v197, s[32:35], s50 offen offset:0 lds
    s_waitcnt lgkmcnt(14)
    v_mfma_f32_32x32x16_bf16 v[96:111], v[152:155], v[244:247], v[96:111]
    ds_read_b64_tr_b16 v[136:137], v194 offset:12288
    ds_read_b64_tr_b16 v[138:139], v194 offset:13312
    s_add_u32 m0, s46, 131072
    s_nop 0
    buffer_load_dwordx4 v199, s[28:31], s51 offen offset:0 lds
    s_waitcnt lgkmcnt(14)
    v_mfma_f32_32x32x16_bf16 v[112:127], v[156:159], v[244:247], v[112:127]
    ds_read_b64_tr_b16 v[140:141], v195 offset:12288
    ds_read_b64_tr_b16 v[142:143], v195 offset:13312
    s_waitcnt lgkmcnt(14)
    v_mfma_f32_32x32x16_bf16 v[64:79], v[160:163], v[248:251], v[64:79]
    s_add_u32 m0, s46, 132096
    s_add_u32 s51, s51, 0x2000
    buffer_load_dwordx4 v200, s[28:31], s51 offen offset:0 lds
    s_waitcnt lgkmcnt(12)
    v_mfma_f32_32x32x16_bf16 v[80:95], v[164:167], v[248:251], v[80:95]
    s_add_u32 m0, s46, 133120
    s_add_u32 s51, s51, 0x2000
    buffer_load_dwordx4 v199, s[28:31], s51 offen offset:0 lds
    s_waitcnt lgkmcnt(10)
    v_mfma_f32_32x32x16_bf16 v[96:111], v[168:171], v[248:251], v[96:111]
    s_waitcnt lgkmcnt(8)
    v_mfma_f32_32x32x16_bf16 v[112:127], v[172:175], v[248:251], v[112:127]
    s_add_u32 m0, s46, 134144
    s_add_u32 s51, s51, 0x2000
    buffer_load_dwordx4 v200, s[28:31], s51 offen offset:0 lds
    s_waitcnt vmcnt(16)
    s_waitcnt lgkmcnt(0)
    s_barrier
    ds_read_b128 v[224:227], v201 offset:49152
    ds_read_b128 v[228:231], v202 offset:49152
    ds_read_b128 v[232:235], v203 offset:49152
    ds_read_b128 v[236:239], v204 offset:49152
    ds_read_b64_tr_b16 v[144:145], v192 offset:32768
    ds_read_b64_tr_b16 v[146:147], v192 offset:33792
    ds_read_b64_tr_b16 v[148:149], v193 offset:32768
    ds_read_b64_tr_b16 v[150:151], v193 offset:33792
    ds_read_b64_tr_b16 v[152:153], v194 offset:32768
    ds_read_b64_tr_b16 v[154:155], v194 offset:33792
    ds_read_b64_tr_b16 v[156:157], v195 offset:32768
    ds_read_b64_tr_b16 v[158:159], v195 offset:33792
    ds_read_b64_tr_b16 v[160:161], v192 offset:36864
    ds_read_b64_tr_b16 v[162:163], v192 offset:37888
    ds_read_b64_tr_b16 v[164:165], v193 offset:36864
    ds_read_b64_tr_b16 v[166:167], v193 offset:37888
    ds_read_b64_tr_b16 v[168:169], v194 offset:36864
    ds_read_b64_tr_b16 v[170:171], v194 offset:37888
    ds_read_b64_tr_b16 v[172:173], v195 offset:36864
    ds_read_b64_tr_b16 v[174:175], v195 offset:37888
    v_mfma_f32_32x32x16_bf16 v[64:79], v[128:131], v[252:255], v[64:79]
    v_mfma_f32_32x32x16_bf16 v[80:95], v[132:135], v[252:255], v[80:95]
    v_mfma_f32_32x32x16_bf16 v[96:111], v[136:139], v[252:255], v[96:111]
    v_mfma_f32_32x32x16_bf16 v[112:127], v[140:143], v[252:255], v[112:127]
    s_waitcnt lgkmcnt(14)
    v_mfma_f32_32x32x16_bf16 v[64:79], v[144:147], v[224:227], v[64:79]
    ds_read_b64_tr_b16 v[128:129], v192 offset:40960
    ds_read_b64_tr_b16 v[130:131], v192 offset:41984
    s_add_u32 m0, s46, 0
    s_mov_b32 s44, s97
    buffer_load_dwordx4 v13, s[20:23], s44 offen offset:0 nt lds
    s_waitcnt lgkmcnt(14)
    v_mfma_f32_32x32x16_bf16 v[80:95], v[148:151], v[224:227], v[80:95]
    ds_read_b64_tr_b16 v[132:133], v193 offset:40960
    ds_read_b64_tr_b16 v[134:135], v193 offset:41984
    s_waitcnt lgkmcnt(14)
    v_mfma_f32_32x32x16_bf16 v[96:111], v[152:155], v[224:227], v[96:111]
    ds_read_b64_tr_b16 v[136:137], v194 offset:40960
    ds_read_b64_tr_b16 v[138:139], v194 offset:41984
    s_add_u32 m0, s46, 0
    s_nop 0
    buffer_load_dwordx4 v14, s[20:23], s44 offen offset:1024 nt lds
    s_waitcnt lgkmcnt(14)
    v_mfma_f32_32x32x16_bf16 v[112:127], v[156:159], v[224:227], v[112:127]
    ds_read_b64_tr_b16 v[140:141], v195 offset:40960
    ds_read_b64_tr_b16 v[142:143], v195 offset:41984
    s_add_u32 m0, s46, 0
    s_nop 0
    buffer_load_dwordx4 v15, s[20:23], s44 offen offset:2048 nt lds
    s_waitcnt lgkmcnt(14)
    v_mfma_f32_32x32x16_bf16 v[64:79], v[160:163], v[228:231], v[64:79]
    ds_read_b64_tr_b16 v[144:145], v192 offset:45056
    ds_read_b64_tr_b16 v[146:147], v192 offset:46080
    s_waitcnt lgkmcnt(14)
    v_mfma_f32_32x32x16_bf16 v[80:95], v[164:167], v[228:231], v[80:95]
    ds_read_b64_tr_b16 v[148:149], v193 offset:45056
    ds_read_b64_tr_b16 v[150:151], v193 offset:46080
    s_add_u32 m0, s46, 0
    s_nop 0
    buffer_load_dwordx4 v16, s[20:23], s44 offen offset:3072 nt lds
    s_add_u32 s44, s44, 0x4000
    s_waitcnt lgkmcnt(14)
    v_mfma_f32_32x32x16_bf16 v[96:111], v[168:171], v[228:231], v[96:111]
    ds_read_b64_tr_b16 v[152:153], v194 offset:45056
    ds_read_b64_tr_b16 v[154:155], v194 offset:46080
    s_add_u32 m0, s46, 16384
    s_nop 0
    buffer_load_dwordx4 v13, s[20:23], s44 offen offset:0 nt lds
    s_waitcnt lgkmcnt(14)
    v_mfma_f32_32x32x16_bf16 v[112:127], v[172:175], v[228:231], v[112:127]
    ds_read_b64_tr_b16 v[156:157], v195 offset:45056
    ds_read_b64_tr_b16 v[158:159], v195 offset:46080
    s_waitcnt lgkmcnt(14)
    v_mfma_f32_32x32x16_bf16 v[64:79], v[128:131], v[232:235], v[64:79]
    s_add_u32 m0, s46, 16384
    s_nop 0
    buffer_load_dwordx4 v14, s[20:23], s44 offen offset:1024 nt lds
    s_waitcnt lgkmcnt(12)
    v_mfma_f32_32x32x16_bf16 v[80:95], v[132:135], v[232:235], v[80:95]
    s_add_u32 m0, s46, 16384
    s_nop 0
    buffer_load_dwordx4 v15, s[20:23], s44 offen offset:2048 nt lds
    s_waitcnt lgkmcnt(10)
    v_mfma_f32_32x32x16_bf16 v[96:111], v[136:139], v[232:235], v[96:111]
    s_waitcnt lgkmcnt(8)
    v_mfma_f32_32x32x16_bf16 v[112:127], v[140:143], v[232:235], v[112:127]
    s_add_u32 m0, s46, 16384
    s_nop 0
    buffer_load_dwordx4 v16, s[20:23], s44 offen offset:3072 nt lds
    s_add_u32 s44, s44, 0x4000
    s_waitcnt vmcnt(63)
    s_waitcnt lgkmcnt(0)
    s_barrier
    ds_read_b128 v[240:243], v180 offset:0
    ds_read_b128 v[244:247], v181 offset:0
    ds_read_b128 v[248:251], v182 offset:0
    ds_read_b128 v[252:255], v183 offset:0
    ds_read_b64_tr_b16 v[160:161], v192 offset:49152
    ds_read_b64_tr_b16 v[162:163], v192 offset:50176
    ds_read_b64_tr_b16 v[164:165], v193 offset:49152
    ds_read_b64_tr_b16 v[166:167], v193 offset:50176
    ds_read_b64_tr_b16 v[168:169], v194 offset:49152
    ds_read_b64_tr_b16 v[170:171], v194 offset:50176
    ds_read_b64_tr_b16 v[172:173], v195 offset:49152
    ds_read_b64_tr_b16 v[174:175], v195 offset:50176
    ds_read_b64_tr_b16 v[128:129], v192 offset:53248
    ds_read_b64_tr_b16 v[130:131], v192 offset:54272
    ds_read_b64_tr_b16 v[132:133], v193 offset:53248
    ds_read_b64_tr_b16 v[134:135], v193 offset:54272
    ds_read_b64_tr_b16 v[136:137], v194 offset:53248
    ds_read_b64_tr_b16 v[138:139], v194 offset:54272
    ds_read_b64_tr_b16 v[140:141], v195 offset:53248
    ds_read_b64_tr_b16 v[142:143], v195 offset:54272
    v_mfma_f32_32x32x16_bf16 v[64:79], v[144:147], v[236:239], v[64:79]
    v_mfma_f32_32x32x16_bf16 v[80:95], v[148:151], v[236:239], v[80:95]
    v_mfma_f32_32x32x16_bf16 v[96:111], v[152:155], v[236:239], v[96:111]
    v_mfma_f32_32x32x16_bf16 v[112:127], v[156:159], v[236:239], v[112:127]
    s_waitcnt lgkmcnt(14)
    v_mfma_f32_32x32x16_bf16 v[64:79], v[160:163], v[240:243], v[64:79]
    ds_read_b64_tr_b16 v[144:145], v192 offset:57344
    ds_read_b64_tr_b16 v[146:147], v192 offset:58368
    s_waitcnt lgkmcnt(14)
    v_mfma_f32_32x32x16_bf16 v[80:95], v[164:167], v[240:243], v[80:95]
    ds_read_b64_tr_b16 v[148:149], v193 offset:57344
    ds_read_b64_tr_b16 v[150:151], v193 offset:58368
    s_add_u32 m0, s46, 65536
    s_mov_b32 s45, s97
    buffer_load_dwordx4 v17, s[24:27], s45 offen offset:0 nt lds
    s_waitcnt lgkmcnt(14)
    v_mfma_f32_32x32x16_bf16 v[96:111], v[168:171], v[240:243], v[96:111]
    ds_read_b64_tr_b16 v[152:153], v194 offset:57344
    ds_read_b64_tr_b16 v[154:155], v194 offset:58368
    s_waitcnt lgkmcnt(14)
    v_mfma_f32_32x32x16_bf16 v[112:127], v[172:175], v[240:243], v[112:127]
    ds_read_b64_tr_b16 v[156:157], v195 offset:57344
    ds_read_b64_tr_b16 v[158:159], v195 offset:58368
    s_waitcnt lgkmcnt(14)
    v_mfma_f32_32x32x16_bf16 v[64:79], v[128:131], v[244:247], v[64:79]
    ds_read_b64_tr_b16 v[160:161], v192 offset:61440
    ds_read_b64_tr_b16 v[162:163], v192 offset:62464
    s_add_u32 m0, s46, 65536
    s_nop 0
    buffer_load_dwordx4 v17, s[24:27], s45 offen offset:1024 nt lds
    s_waitcnt lgkmcnt(14)
    v_mfma_f32_32x32x16_bf16 v[80:95], v[132:135], v[244:247], v[80:95]
    ds_read_b64_tr_b16 v[164:165], v193 offset:61440
    ds_read_b64_tr_b16 v[166:167], v193 offset:62464
    s_waitcnt lgkmcnt(14)
    v_mfma_f32_32x32x16_bf16 v[96:111], v[136:139], v[244:247], v[96:111]
    ds_read_b64_tr_b16 v[168:169], v194 offset:61440
    ds_read_b64_tr_b16 v[170:171], v194 offset:62464
    s_waitcnt lgkmcnt(14)
    v_mfma_f32_32x32x16_bf16 v[112:127], v[140:143], v[244:247], v[112:127]
    ds_read_b64_tr_b16 v[172:173], v195 offset:61440
    ds_read_b64_tr_b16 v[174:175], v195 offset:62464
    s_add_u32 m0, s46, 65536
    s_nop 0
    buffer_load_dwordx4 v17, s[24:27], s45 offen offset:2048 nt lds
    s_waitcnt lgkmcnt(14)
    v_mfma_f32_32x32x16_bf16 v[64:79], v[144:147], v[248:251], v[64:79]
    s_waitcnt lgkmcnt(12)
    v_mfma_f32_32x32x16_bf16 v[80:95], v[148:151], v[248:251], v[80:95]
    s_waitcnt lgkmcnt(10)
    v_mfma_f32_32x32x16_bf16 v[96:111], v[152:155], v[248:251], v[96:111]
    s_add_u32 m0, s46, 65536
    s_nop 0
    buffer_load_dwordx4 v17, s[24:27], s45 offen offset:3072 nt lds
    s_add_u32 s45, s45, 0x4000
    s_waitcnt lgkmcnt(8)
    v_mfma_f32_32x32x16_bf16 v[112:127], v[156:159], v[248:251], v[112:127]
    s_waitcnt vmcnt(20)
    s_waitcnt lgkmcnt(0)
    s_barrier
    ds_read_b128 v[224:227], v180 offset:32768
    ds_read_b128 v[228:231], v181 offset:32768
    ds_read_b128 v[232:235], v182 offset:32768
    ds_read_b128 v[236:239], v183 offset:32768
    ds_read_b64_tr_b16 v[128:129], v176 offset:0
    ds_read_b64_tr_b16 v[130:131], v176 offset:1024
    ds_read_b64_tr_b16 v[132:133], v177 offset:0
    ds_read_b64_tr_b16 v[134:135], v177 offset:1024
    ds_read_b64_tr_b16 v[136:137], v178 offset:0
    ds_read_b64_tr_b16 v[138:139], v178 offset:1024
    ds_read_b64_tr_b16 v[140:141], v179 offset:0
    ds_read_b64_tr_b16 v[142:143], v179 offset:1024
    ds_read_b64_tr_b16 v[144:145], v176 offset:4096
    ds_read_b64_tr_b16 v[146:147], v176 offset:5120
    ds_read_b64_tr_b16 v[148:149], v177 offset:4096
    ds_read_b64_tr_b16 v[150:151], v177 offset:5120
    ds_read_b64_tr_b16 v[152:153], v178 offset:4096
    ds_read_b64_tr_b16 v[154:155], v178 offset:5120
    ds_read_b64_tr_b16 v[156:157], v179 offset:4096
    ds_read_b64_tr_b16 v[158:159], v179 offset:5120
    v_mfma_f32_32x32x16_bf16 v[64:79], v[160:163], v[252:255], v[64:79]
    v_mfma_f32_32x32x16_bf16 v[80:95], v[164:167], v[252:255], v[80:95]
    v_mfma_f32_32x32x16_bf16 v[96:111], v[168:171], v[252:255], v[96:111]
    v_mfma_f32_32x32x16_bf16 v[112:127], v[172:175], v[252:255], v[112:127]
    s_waitcnt lgkmcnt(14)
    v_mfma_f32_32x32x16_bf16 v[64:79], v[128:131], v[224:227], v[64:79]
    ds_read_b64_tr_b16 v[160:161], v176 offset:8192
    ds_read_b64_tr_b16 v[162:163], v176 offset:9216
    s_waitcnt lgkmcnt(14)
    v_mfma_f32_32x32x16_bf16 v[80:95], v[132:135], v[224:227], v[80:95]
    ds_read_b64_tr_b16 v[164:165], v177 offset:8192
    ds_read_b64_tr_b16 v[166:167], v177 offset:9216
    s_add_u32 m0, s46, 32768
    s_nop 0
    buffer_load_dwordx4 v13, s[20:23], s44 offen offset:0 nt lds
    s_waitcnt lgkmcnt(14)
    v_mfma_f32_32x32x16_bf16 v[96:111], v[136:139], v[224:227], v[96:111]
    ds_read_b64_tr_b16 v[168:169], v178 offset:8192
    ds_read_b64_tr_b16 v[170:171], v178 offset:9216
    s_waitcnt lgkmcnt(14)
    v_mfma_f32_32x32x16_bf16 v[112:127], v[140:143], v[224:227], v[112:127]
    ds_read_b64_tr_b16 v[172:173], v179 offset:8192
    ds_read_b64_tr_b16 v[174:175], v179 offset:9216
    s_waitcnt lgkmcnt(14)
    v_mfma_f32_32x32x16_bf16 v[64:79], v[144:147], v[228:231], v[64:79]
    ds_read_b64_tr_b16 v[128:129], v176 offset:12288
    ds_read_b64_tr_b16 v[130:131], v176 offset:13312
    s_add_u32 m0, s46, 32768
    s_nop 0
    buffer_load_dwordx4 v14, s[20:23], s44 offen offset:1024 nt lds
    s_waitcnt lgkmcnt(14)
    v_mfma_f32_32x32x16_bf16 v[80:95], v[148:151], v[228:231], v[80:95]
    ds_read_b64_tr_b16 v[132:133], v177 offset:12288
    ds_read_b64_tr_b16 v[134:135], v177 offset:13312
    s_waitcnt lgkmcnt(14)
    v_mfma_f32_32x32x16_bf16 v[96:111], v[152:155], v[228:231], v[96:111]
    ds_read_b64_tr_b16 v[136:137], v178 offset:12288
    ds_read_b64_tr_b16 v[138:139], v178 offset:13312
    s_waitcnt lgkmcnt(14)
    v_mfma_f32_32x32x16_bf16 v[112:127], v[156:159], v[228:231], v[112:127]
    ds_read_b64_tr_b16 v[140:141], v179 offset:12288
    ds_read_b64_tr_b16 v[142:143], v179 offset:13312
    s_add_u32 m0, s46, 32768
    s_nop 0
    buffer_load_dwordx4 v15, s[20:23], s44 offen offset:2048 nt lds
    s_waitcnt lgkmcnt(14)
    v_mfma_f32_32x32x16_bf16 v[64:79], v[160:163], v[232:235], v[64:79]
    s_waitcnt lgkmcnt(12)
    v_mfma_f32_32x32x16_bf16 v[80:95], v[164:167], v[232:235], v[80:95]
    s_waitcnt lgkmcnt(10)
    v_mfma_f32_32x32x16_bf16 v[96:111], v[168:171], v[232:235], v[96:111]
    s_add_u32 m0, s46, 32768
    s_nop 0
    buffer_load_dwordx4 v16, s[20:23], s44 offen offset:3072 nt lds
    s_add_u32 s44, s44, 0x4000
    s_waitcnt lgkmcnt(8)
    v_mfma_f32_32x32x16_bf16 v[112:127], v[172:175], v[232:235], v[112:127]
    s_waitcnt vmcnt(12)
    s_waitcnt lgkmcnt(0)
    s_barrier
    ds_read_b128 v[240:243], v180 offset:49152
    ds_read_b128 v[244:247], v181 offset:49152
    ds_read_b128 v[248:251], v182 offset:49152
    ds_read_b128 v[252:255], v183 offset:49152
    ds_read_b64_tr_b16 v[144:145], v176 offset:49152
    ds_read_b64_tr_b16 v[146:147], v176 offset:50176
    ds_read_b64_tr_b16 v[148:149], v176 offset:53248
    ds_read_b64_tr_b16 v[150:151], v176 offset:54272
    ds_read_b64_tr_b16 v[152:153], v176 offset:57344
    ds_read_b64_tr_b16 v[154:155], v176 offset:58368
    ds_read_b64_tr_b16 v[156:157], v176 offset:61440
    ds_read_b64_tr_b16 v[158:159], v176 offset:62464
    ds_read_b64_tr_b16 v[160:161], v177 offset:49152
    ds_read_b64_tr_b16 v[162:163], v177 offset:50176
    ds_read_b64_tr_b16 v[164:165], v177 offset:53248
    ds_read_b64_tr_b16 v[166:167], v177 offset:54272
    ds_read_b64_tr_b16 v[168:169], v177 offset:57344
    ds_read_b64_tr_b16 v[170:171], v177 offset:58368
    ds_read_b64_tr_b16 v[172:173], v177 offset:61440
    ds_read_b64_tr_b16 v[174:175], v177 offset:62464
    v_mfma_f32_32x32x16_bf16 v[64:79], v[128:131], v[236:239], v[64:79]
    v_mfma_f32_32x32x16_bf16 v[80:95], v[132:135], v[236:239], v[80:95]
    v_mfma_f32_32x32x16_bf16 v[96:111], v[136:139], v[236:239], v[96:111]
    v_mfma_f32_32x32x16_bf16 v[112:127], v[140:143], v[236:239], v[112:127]
    s_mov_b32 s96, 0x3e0293ee
    v_mov_b32 v26, 0
    s_mov_b32 s56, 0x20000
    s_waitcnt lgkmcnt(14)
    v_mfma_f32_32x32x16_bf16 v[64:79], v[144:147], v[240:243], v[64:79]
    ds_read_b64_tr_b16 v[128:129], v178 offset:49152
    ds_read_b64_tr_b16 v[130:131], v178 offset:50176
    s_waitcnt lgkmcnt(14)
    v_mfma_f32_32x32x16_bf16 v[64:79], v[148:151], v[244:247], v[64:79]
    ds_read_b64_tr_b16 v[132:133], v178 offset:53248
    ds_read_b64_tr_b16 v[134:135], v178 offset:54272
    s_waitcnt lgkmcnt(14)
    v_mfma_f32_32x32x16_bf16 v[64:79], v[152:155], v[248:251], v[64:79]
    ds_read_b64_tr_b16 v[136:137], v178 offset:57344
    ds_read_b64_tr_b16 v[138:139], v178 offset:58368
    s_waitcnt lgkmcnt(14)
    v_mfma_f32_32x32x16_bf16 v[64:79], v[156:159], v[252:255], v[64:79]
    ds_read_b64_tr_b16 v[140:141], v178 offset:61440
    ds_read_b64_tr_b16 v[142:143], v178 offset:62464
    s_waitcnt lgkmcnt(14)
    v_mfma_f32_32x32x16_bf16 v[80:95], v[160:163], v[240:243], v[80:95]
    ds_read_b64_tr_b16 v[144:145], v179 offset:49152
    ds_read_b64_tr_b16 v[146:147], v179 offset:50176
    s_waitcnt lgkmcnt(14)
    v_mfma_f32_32x32x16_bf16 v[80:95], v[164:167], v[244:247], v[80:95]
    ds_read_b64_tr_b16 v[148:149], v179 offset:53248
    ds_read_b64_tr_b16 v[150:151], v179 offset:54272
    s_nop 1
    v_mul_f32 v64, s96, v64
    v_mul_f32 v65, s96, v65
    v_cvt_pk_bf16_f32 v32, v64, v65
    v_mul_f32 v66, s96, v66
    v_mul_f32 v67, s96, v67
    v_cvt_pk_bf16_f32 v33, v66, v67
    s_waitcnt lgkmcnt(14)
    v_mfma_f32_32x32x16_bf16 v[80:95], v[168:171], v[248:251], v[80:95]
    ds_read_b64_tr_b16 v[152:153], v179 offset:57344
    ds_read_b64_tr_b16 v[154:155], v179 offset:58368
    v_mul_f32 v68, s96, v68
    v_mul_f32 v69, s96, v69
    v_cvt_pk_bf16_f32 v34, v68, v69
    v_mul_f32 v70, s96, v70
    v_mul_f32 v71, s96, v71
    v_cvt_pk_bf16_f32 v35, v70, v71
    s_waitcnt lgkmcnt(14)
    v_mfma_f32_32x32x16_bf16 v[80:95], v[172:175], v[252:255], v[80:95]
    ds_read_b64_tr_b16 v[156:157], v179 offset:61440
    ds_read_b64_tr_b16 v[158:159], v179 offset:62464
    v_mul_f32 v72, s96, v72
    v_mul_f32 v73, s96, v73
    v_cvt_pk_bf16_f32 v36, v72, v73
    v_mul_f32 v74, s96, v74
    v_mul_f32 v75, s96, v75
    v_cvt_pk_bf16_f32 v37, v74, v75
    s_waitcnt lgkmcnt(14)
    v_mfma_f32_32x32x16_bf16 v[96:111], v[128:131], v[240:243], v[96:111]
    v_mul_f32 v76, s96, v76
    v_mul_f32 v77, s96, v77
    v_cvt_pk_bf16_f32 v38, v76, v77
    v_mul_f32 v78, s96, v78
    v_mul_f32 v79, s96, v79
    v_cvt_pk_bf16_f32 v39, v78, v79
    s_waitcnt lgkmcnt(12)
    v_mfma_f32_32x32x16_bf16 v[96:111], v[132:135], v[244:247], v[96:111]
    v_mul_f32 v80, s96, v80
    v_mul_f32 v81, s96, v81
    v_cvt_pk_bf16_f32 v40, v80, v81
    v_mul_f32 v82, s96, v82
    v_mul_f32 v83, s96, v83
    v_cvt_pk_bf16_f32 v41, v82, v83
    s_waitcnt lgkmcnt(10)
    v_mfma_f32_32x32x16_bf16 v[96:111], v[136:139], v[248:251], v[96:111]
    ds_read_b128 v[208:211], v1 offset:0
    v_mul_f32 v84, s96, v84
    v_mul_f32 v85, s96, v85
    v_cvt_pk_bf16_f32 v42, v84, v85
    v_mul_f32 v86, s96, v86
    v_mul_f32 v87, s96, v87
    v_cvt_pk_bf16_f32 v43, v86, v87
    s_waitcnt lgkmcnt(9)
    v_mfma_f32_32x32x16_bf16 v[96:111], v[140:143], v[252:255], v[96:111]
    ds_read_b128 v[212:215], v2 offset:0
    v_mul_f32 v88, s96, v88
    v_mul_f32 v89, s96, v89
    v_cvt_pk_bf16_f32 v44, v88, v89
    v_mul_f32 v90, s96, v90
    v_mul_f32 v91, s96, v91
    v_cvt_pk_bf16_f32 v45, v90, v91
    s_waitcnt lgkmcnt(8)
    v_mfma_f32_32x32x16_bf16 v[112:127], v[144:147], v[240:243], v[112:127]
    ds_read_b128 v[216:219], v3 offset:0
    v_mul_f32 v92, s96, v92
    v_mul_f32 v93, s96, v93
    v_cvt_pk_bf16_f32 v46, v92, v93
    v_mul_f32 v94, s96, v94
    v_mul_f32 v95, s96, v95
    v_cvt_pk_bf16_f32 v47, v94, v95
    s_waitcnt lgkmcnt(7)
    v_mfma_f32_32x32x16_bf16 v[112:127], v[148:151], v[244:247], v[112:127]
    ds_read_b128 v[220:223], v4 offset:0
    v_mul_f32 v96, s96, v96
    v_mul_f32 v97, s96, v97
    v_cvt_pk_bf16_f32 v48, v96, v97
    v_mul_f32 v98, s96, v98
    v_mul_f32 v99, s96, v99
    v_cvt_pk_bf16_f32 v49, v98, v99
    s_waitcnt lgkmcnt(6)
    v_mfma_f32_32x32x16_bf16 v[112:127], v[152:155], v[248:251], v[112:127]
    ds_read_b128 v[224:227], v5 offset:0
    v_mul_f32 v100, s96, v100
    v_mul_f32 v101, s96, v101
    v_cvt_pk_bf16_f32 v50, v100, v101
    v_mul_f32 v102, s96, v102
    v_mul_f32 v103, s96, v103
    v_cvt_pk_bf16_f32 v51, v102, v103
    s_waitcnt lgkmcnt(5)
    v_mfma_f32_32x32x16_bf16 v[112:127], v[156:159], v[252:255], v[112:127]
    ds_read_b128 v[228:231], v6 offset:0
    v_mul_f32 v104, s96, v104
    v_mul_f32 v105, s96, v105
    v_cvt_pk_bf16_f32 v52, v104, v105
    v_mul_f32 v106, s96, v106
    v_mul_f32 v107, s96, v107
    v_cvt_pk_bf16_f32 v53, v106, v107
    s_waitcnt lgkmcnt(5)
    v_mfma_f32_32x32x16_bf16 v[128:143], v[208:211], v[32:35], 0
    ds_read_b128 v[208:211], v7 offset:0
    s_add_u32 m0, s46, 81920
    s_nop 0
    buffer_load_dwordx4 v17, s[24:27], s45 offen offset:0 nt lds
    v_mul_f32 v108, s96, v108
    v_mul_f32 v109, s96, v109
    v_cvt_pk_bf16_f32 v54, v108, v109
    v_mul_f32 v110, s96, v110
    v_mul_f32 v111, s96, v111
    v_cvt_pk_bf16_f32 v55, v110, v111
    v_mov_b32 v64, 0
    s_waitcnt lgkmcnt(5)
    v_mfma_f32_32x32x16_bf16 v[128:143], v[212:215], v[36:39], v[128:143]
    ds_read_b128 v[212:215], v8 offset:0
    s_add_u32 m0, s46, 81920
    s_nop 0
    buffer_load_dwordx4 v17, s[24:27], s45 offen offset:1024 nt lds
    v_mov_b32 v65, 0
    v_mov_b32 v66, 0
    v_mov_b32 v67, 0
    v_mov_b32 v68, 0
    v_mov_b32 v69, 0
    v_mov_b32 v70, 0
    v_mov_b32 v71, 0
    s_waitcnt lgkmcnt(5)
    v_mfma_f32_32x32x16_bf16 v[128:143], v[216:219], v[40:43], v[128:143]
    ds_read_b128 v[216:219], v1 offset:8192
    s_add_u32 m0, s46, 81920
    s_nop 0
    buffer_load_dwordx4 v17, s[24:27], s45 offen offset:2048 nt lds
    v_mov_b32 v72, 0
    v_mov_b32 v73, 0
    v_mov_b32 v74, 0
    v_mov_b32 v75, 0
    v_mov_b32 v76, 0
    v_mov_b32 v77, 0
    v_mov_b32 v78, 0
    s_waitcnt lgkmcnt(5)
    v_mfma_f32_32x32x16_bf16 v[128:143], v[220:223], v[44:47], v[128:143]
    ds_read_b128 v[220:223], v2 offset:8192
    s_add_u32 m0, s46, 81920
    s_nop 0
    buffer_load_dwordx4 v17, s[24:27], s45 offen offset:3072 nt lds
    s_add_u32 s45, s45, 0x4000
    v_mov_b32 v79, 0
    v_mov_b32 v80, 0
    v_mov_b32 v81, 0
    v_mov_b32 v82, 0
    v_mov_b32 v83, 0
    v_mov_b32 v84, 0
    v_mov_b32 v85, 0
    s_waitcnt lgkmcnt(5)
    v_mfma_f32_32x32x16_bf16 v[128:143], v[224:227], v[48:51], v[128:143]
    ds_read_b128 v[224:227], v3 offset:8192
    s_add_u32 m0, s46, 49152
    s_nop 0
    buffer_load_dwordx4 v13, s[20:23], s44 offen offset:0 nt lds
    v_mov_b32 v86, 0
    v_mov_b32 v87, 0
    v_mov_b32 v88, 0
    v_mov_b32 v89, 0
    v_mov_b32 v90, 0
    v_mov_b32 v91, 0
    v_mov_b32 v92, 0
    s_waitcnt lgkmcnt(5)
    v_mfma_f32_32x32x16_bf16 v[128:143], v[228:231], v[52:55], v[128:143]
    ds_read_b128 v[228:231], v4 offset:8192
    s_add_u32 m0, s46, 49152
    s_nop 0
    buffer_load_dwordx4 v14, s[20:23], s44 offen offset:1024 nt lds
    v_mov_b32 v93, 0
    v_mov_b32 v94, 0
    v_mov_b32 v95, 0
    v_mul_f32 v112, s96, v112
    v_mul_f32 v113, s96, v113
    v_cvt_pk_bf16_f32 v56, v112, v113
    v_mul_f32 v114, s96, v114
    v_mul_f32 v115, s96, v115
    v_cvt_pk_bf16_f32 v57, v114, v115
    v_mul_f32 v116, s96, v116
    v_mul_f32 v117, s96, v117
    v_cvt_pk_bf16_f32 v58, v116, v117
    v_mul_f32 v118, s96, v118
    v_mul_f32 v119, s96, v119
    v_cvt_pk_bf16_f32 v59, v118, v119
    v_mul_f32 v120, s96, v120
    v_mul_f32 v121, s96, v121
    v_cvt_pk_bf16_f32 v60, v120, v121
    v_mul_f32 v122, s96, v122
    v_mul_f32 v123, s96, v123
    v_cvt_pk_bf16_f32 v61, v122, v123
    v_mul_f32 v124, s96, v124
    v_mul_f32 v125, s96, v125
    v_cvt_pk_bf16_f32 v62, v124, v125
    v_mul_f32 v126, s96, v126
    v_mul_f32 v127, s96, v127
    v_cvt_pk_bf16_f32 v63, v126, v127
    s_waitcnt lgkmcnt(5)
    v_mfma_f32_32x32x16_bf16 v[128:143], v[208:211], v[56:59], v[128:143]
    ds_read_b128 v[208:211], v5 offset:8192
    s_add_u32 m0, s46, 49152
    s_nop 0
    buffer_load_dwordx4 v15, s[20:23], s44 offen offset:2048 nt lds
    v_mov_b32 v96, 0
    v_mov_b32 v97, 0
    v_mov_b32 v98, 0
    v_mov_b32 v99, 0
    v_mov_b32 v100, 0
    v_mov_b32 v101, 0
    v_mov_b32 v102, 0
    s_waitcnt lgkmcnt(5)
    v_mfma_f32_32x32x16_bf16 v[128:143], v[212:215], v[60:63], v[128:143]
    ds_read_b128 v[212:215], v6 offset:8192
    s_add_u32 m0, s46, 49152
    s_nop 0
    buffer_load_dwordx4 v16, s[20:23], s44 offen offset:3072 nt lds
    s_add_u32 s44, s44, 0x4000
    v_mov_b32 v103, 0
    v_mov_b32 v104, 0
    v_mov_b32 v105, 0
    v_mov_b32 v106, 0
    v_mov_b32 v107, 0
    v_mov_b32 v108, 0
    v_mov_b32 v109, 0
    s_waitcnt lgkmcnt(5)
    v_mfma_f32_32x32x16_bf16 v[144:159], v[216:219], v[32:35], 0
    ds_read_b128 v[216:219], v7 offset:8192
    s_add_u32 m0, s46, 98304
    s_nop 0
    buffer_load_dwordx4 v17, s[24:27], s45 offen offset:0 nt lds
    v_mov_b32 v110, 0
    v_mov_b32 v111, 0
    v_mov_b32 v112, 0
    v_mov_b32 v113, 0
    v_mov_b32 v114, 0
    v_mov_b32 v115, 0
    v_mov_b32 v116, 0
    s_waitcnt lgkmcnt(5)
    v_mfma_f32_32x32x16_bf16 v[144:159], v[220:223], v[36:39], v[144:159]
    ds_read_b128 v[220:223], v8 offset:8192
    s_add_u32 m0, s46, 98304
    s_nop 0
    buffer_load_dwordx4 v17, s[24:27], s45 offen offset:1024 nt lds
    v_mov_b32 v117, 0
    v_mov_b32 v118, 0
    v_mov_b32 v119, 0
    v_mov_b32 v120, 0
    v_mov_b32 v121, 0
    v_mov_b32 v122, 0
    v_mov_b32 v123, 0
    s_waitcnt lgkmcnt(5)
    v_mfma_f32_32x32x16_bf16 v[144:159], v[224:227], v[40:43], v[144:159]
    s_add_u32 m0, s46, 98304
    s_nop 0
    buffer_load_dwordx4 v17, s[24:27], s45 offen offset:2048 nt lds
    v_mov_b32 v124, 0
    v_mov_b32 v125, 0
    v_mov_b32 v126, 0
    v_mov_b32 v127, 0
    s_waitcnt lgkmcnt(4)
    v_mfma_f32_32x32x16_bf16 v[144:159], v[228:231], v[44:47], v[144:159]
    s_add_u32 m0, s46, 98304
    s_nop 0
    buffer_load_dwordx4 v17, s[24:27], s45 offen offset:3072 nt lds
    s_add_u32 s45, s45, 0x4000
    s_waitcnt lgkmcnt(3)
    v_mfma_f32_32x32x16_bf16 v[144:159], v[208:211], v[48:51], v[144:159]
    s_waitcnt lgkmcnt(2)
    v_mfma_f32_32x32x16_bf16 v[144:159], v[212:215], v[52:55], v[144:159]
    s_waitcnt lgkmcnt(1)
    v_mfma_f32_32x32x16_bf16 v[144:159], v[216:219], v[56:59], v[144:159]
    s_waitcnt lgkmcnt(0)
    v_mfma_f32_32x32x16_bf16 v[144:159], v[220:223], v[60:63], v[144:159]
    v_mov_b32 v18, 0
    v_mov_b32 v19, 0
    v_max3_f32 v20, v128, v129, v130
    v_max3_f32 v20, v20, v131, v132
    v_max3_f32 v20, v20, v133, v134
    v_max3_f32 v20, v20, v135, v136
    v_max3_f32 v20, v20, v137, v138
    v_max3_f32 v20, v20, v139, v140
    v_max3_f32 v20, v20, v141, v142
    v_max_f32 v20, v20, v143
    s_nop 1
    v_max3_f32 v20, v20, v144, v145
    v_max3_f32 v20, v20, v146, v147
    v_max3_f32 v20, v20, v148, v149
    v_max3_f32 v20, v20, v150, v151
    v_max3_f32 v20, v20, v152, v153
    v_max3_f32 v20, v20, v154, v155
    v_max3_f32 v20, v20, v156, v157
    v_max3_f32 v20, v20, v158, v159
    v_mov_b32 v21, v20
    s_nop 1
    v_permlane32_swap_b32 v20, v21
    v_max_f32 v20, v20, v21
    v_sub_f32 v128, v128, v20
    v_sub_f32 v129, v129, v20
    v_sub_f32 v130, v130, v20
    v_sub_f32 v131, v131, v20
    v_sub_f32 v132, v132, v20
    v_sub_f32 v133, v133, v20
    v_sub_f32 v134, v134, v20
    v_sub_f32 v135, v135, v20
    v_sub_f32 v136, v136, v20
    v_sub_f32 v137, v137, v20
    v_sub_f32 v138, v138, v20
    v_sub_f32 v139, v139, v20
    v_sub_f32 v140, v140, v20
    v_sub_f32 v141, v141, v20
    v_sub_f32 v142, v142, v20
    v_sub_f32 v143, v143, v20
    v_sub_f32 v144, v144, v20
    v_sub_f32 v145, v145, v20
    v_sub_f32 v146, v146, v20
    v_sub_f32 v147, v147, v20
    v_sub_f32 v148, v148, v20
    v_sub_f32 v149, v149, v20
    v_sub_f32 v150, v150, v20
    v_sub_f32 v151, v151, v20
    v_sub_f32 v152, v152, v20
    v_sub_f32 v153, v153, v20
    v_sub_f32 v154, v154, v20
    v_sub_f32 v155, v155, v20
    v_sub_f32 v156, v156, v20
    v_sub_f32 v157, v157, v20
    v_sub_f32 v158, v158, v20
    v_sub_f32 v159, v159, v20
    v_sub_f32 v192, 0, v20
    v_sub_f32 v193, 0, v20
    v_sub_f32 v194, 0, v20
    v_sub_f32 v195, 0, v20
    v_sub_f32 v196, 0, v20
    v_sub_f32 v197, 0, v20
    v_sub_f32 v198, 0, v20
    v_sub_f32 v199, 0, v20
    v_sub_f32 v200, 0, v20
    v_sub_f32 v201, 0, v20
    v_sub_f32 v202, 0, v20
    v_sub_f32 v203, 0, v20
    v_sub_f32 v204, 0, v20
    v_sub_f32 v205, 0, v20
    v_sub_f32 v206, 0, v20
    v_sub_f32 v207, 0, v20
    buffer_load_dword v26, v26, s[80:83], 0 offen offset:0 sc1
    s_mov_b32 s43, 0
L_loop:
    s_cmp_lg_u32 s43, 0
    s_cbranch_scc1 L_vmskip_0
    s_waitcnt vmcnt(17)
L_vmskip_0:
    s_waitcnt vmcnt(24)
    s_barrier
    ds_read_b128 v[208:211], v1 offset:16384
    ds_read_b128 v[212:215], v2 offset:16384
    ds_read_b128 v[216:219], v3 offset:16384
    ds_read_b128 v[220:223], v4 offset:16384
    ds_read_b128 v[224:227], v5 offset:16384
    ds_read_b128 v[228:231], v6 offset:16384
    v_exp_f32 v128, v128
    v_exp_f32 v129, v129
    v_exp_f32 v130, v130
    v_exp_f32 v131, v131
    s_waitcnt lgkmcnt(5)
    v_mfma_f32_32x32x16_bf16 v[160:175], v[208:211], v[32:35], v[192:207]
    ds_read_b128 v[208:211], v7 offset:16384
    s_add_u32 m0, s46, 0
    s_nop 0
    buffer_load_dwordx4 v13, s[20:23], s44 offen offset:0 nt lds
    v_add_f32 v18, v18, v128
    v_add_f32 v19, v19, v129
    v_exp_f32 v132, v132
    s_waitcnt lgkmcnt(5)
    v_mfma_f32_32x32x16_bf16 v[160:175], v[212:215], v[36:39], v[160:175]
    ds_read_b128 v[212:215], v8 offset:16384
    s_add_u32 m0, s46, 0
    s_nop 0
    buffer_load_dwordx4 v14, s[20:23], s44 offen offset:1024 nt lds
    v_add_f32 v18, v18, v130
    v_exp_f32 v133, v133
    v_add_f32 v19, v19, v131
    s_waitcnt lgkmcnt(5)
    v_mfma_f32_32x32x16_bf16 v[160:175], v[216:219], v[40:43], v[160:175]
    ds_read_b128 v[216:219], v1 offset:24576
    s_add_u32 m0, s46, 0
    s_nop 0
    buffer_load_dwordx4 v15, s[20:23], s44 offen offset:2048 nt lds
    v_cvt_pk_bf16_f32 v128, v128, v129
    v_exp_f32 v134, v134
    v_add_f32 v18, v18, v132
    s_waitcnt lgkmcnt(5)
    v_mfma_f32_32x32x16_bf16 v[160:175], v[220:223], v[44:47], v[160:175]
    ds_read_b128 v[220:223], v2 offset:24576
    s_add_u32 m0, s46, 0
    s_nop 0
    buffer_load_dwordx4 v16, s[20:23], s44 offen offset:3072 nt lds
    s_add_u32 s44, s44, 0x4000
    v_exp_f32 v135, v135
    v_add_f32 v19, v19, v133
    v_cvt_pk_bf16_f32 v129, v130, v131
    s_waitcnt lgkmcnt(5)
    v_mfma_f32_32x32x16_bf16 v[160:175], v[224:227], v[48:51], v[160:175]
    ds_read_b128 v[224:227], v3 offset:24576
    s_add_u32 m0, s46, 114688
    s_nop 0
    buffer_load_dwordx4 v17, s[24:27], s45 offen offset:0 nt lds
    v_add_f32 v18, v18, v134
    v_add_f32 v19, v19, v135
    v_cvt_pk_bf16_f32 v130, v132, v133
    v_cvt_pk_bf16_f32 v131, v134, v135
    s_waitcnt lgkmcnt(5)
    v_mfma_f32_32x32x16_bf16 v[160:175], v[228:231], v[52:55], v[160:175]
    ds_read_b128 v[228:231], v4 offset:24576
    s_add_u32 m0, s46, 114688
    s_nop 0
    buffer_load_dwordx4 v17, s[24:27], s45 offen offset:1024 nt lds
    v_exp_f32 v136, v136
    v_exp_f32 v137, v137
    s_waitcnt lgkmcnt(5)
    v_mfma_f32_32x32x16_bf16 v[160:175], v[208:211], v[56:59], v[160:175]
    ds_read_b128 v[208:211], v5 offset:24576
    ds_read_b64_tr_b16 v[232:233], v9 offset:0
    ds_read_b64_tr_b16 v[234:235], v9 offset:2048
    s_add_u32 m0, s46, 114688
    s_nop 0
    buffer_load_dwordx4 v17, s[24:27], s45 offen offset:2048 nt lds
    v_exp_f32 v138, v138
    v_exp_f32 v139, v139
    s_waitcnt lgkmcnt(7)
    v_mfma_f32_32x32x16_bf16 v[160:175], v[212:215], v[60:63], v[160:175]
    ds_read_b128 v[212:215], v6 offset:24576
    ds_read_b64_tr_b16 v[236:237], v10 offset:0
    ds_read_b64_tr_b16 v[238:239], v10 offset:2048
    s_add_u32 m0, s46, 114688
    s_nop 0
    buffer_load_dwordx4 v17, s[24:27], s45 offen offset:3072 nt lds
    s_add_u32 s45, s45, 0x4000
    v_add_f32 v18, v18, v136
    v_add_f32 v19, v19, v137
    v_exp_f32 v140, v140
    s_waitcnt lgkmcnt(9)
    v_mfma_f32_32x32x16_bf16 v[176:191], v[216:219], v[32:35], v[192:207]
    ds_read_b128 v[216:219], v7 offset:24576
    ds_read_b64_tr_b16 v[240:241], v11 offset:0
    ds_read_b64_tr_b16 v[242:243], v11 offset:2048
    v_add_f32 v18, v18, v138
    v_exp_f32 v141, v141
    v_add_f32 v19, v19, v139
    s_waitcnt lgkmcnt(11)
    v_mfma_f32_32x32x16_bf16 v[176:191], v[220:223], v[36:39], v[176:191]
    ds_read_b128 v[220:223], v8 offset:24576
    ds_read_b64_tr_b16 v[244:245], v12 offset:0
    ds_read_b64_tr_b16 v[246:247], v12 offset:2048
    v_cvt_pk_bf16_f32 v136, v136, v137
    v_exp_f32 v142, v142
    v_add_f32 v18, v18, v140
    s_waitcnt lgkmcnt(13)
    v_mfma_f32_32x32x16_bf16 v[176:191], v[224:227], v[40:43], v[176:191]
    ds_read_b64_tr_b16 v[248:249], v9 offset:4096
    ds_read_b64_tr_b16 v[250:251], v9 offset:6144
    v_exp_f32 v143, v143
    v_add_f32 v19, v19, v141
    v_cvt_pk_bf16_f32 v137, v138, v139
    s_waitcnt lgkmcnt(14)
    v_mfma_f32_32x32x16_bf16 v[176:191], v[228:231], v[44:47], v[176:191]
    ds_read_b64_tr_b16 v[252:253], v10 offset:4096
    ds_read_b64_tr_b16 v[254:255], v10 offset:6144
    v_add_f32 v18, v18, v142
    v_add_f32 v19, v19, v143
    v_cvt_pk_bf16_f32 v138, v140, v141
    v_cvt_pk_bf16_f32 v139, v142, v143
    v_max3_f32 v20, v160, v161, v162
    v_max3_f32 v20, v20, v163, v164
    s_waitcnt lgkmcnt(15)
    v_mfma_f32_32x32x16_bf16 v[176:191], v[208:211], v[48:51], v[176:191]
    v_exp_f32 v144, v144
    v_exp_f32 v145, v145
    v_max3_f32 v20, v20, v165, v166
    v_max3_f32 v20, v20, v167, v168
    s_waitcnt lgkmcnt(12)
    v_mfma_f32_32x32x16_bf16 v[176:191], v[212:215], v[52:55], v[176:191]
    v_exp_f32 v146, v146
    v_exp_f32 v147, v147
    v_max3_f32 v20, v20, v169, v170
    v_max3_f32 v20, v20, v171, v172
    s_waitcnt lgkmcnt(9)
    v_mfma_f32_32x32x16_bf16 v[176:191], v[216:219], v[56:59], v[176:191]
    v_add_f32 v18, v18, v144
    v_add_f32 v19, v19, v145
    v_exp_f32 v148, v148
    v_max3_f32 v20, v20, v173, v174
    v_max_f32 v20, v20, v175
    s_waitcnt lgkmcnt(6)
    v_mfma_f32_32x32x16_bf16 v[176:191], v[220:223], v[60:63], v[176:191]
    v_add_f32 v18, v18, v146
    v_exp_f32 v149, v149
    v_add_f32 v19, v19, v147
    v_mfma_f32_32x32x16_bf16 v[64:79], v[232:235], v[128:131], v[64:79]
    ds_read_b64_tr_b16 v[232:233], v11 offset:4096
    ds_read_b64_tr_b16 v[234:235], v11 offset:6144
    v_cvt_pk_bf16_f32 v144, v144, v145
    v_exp_f32 v150, v150
    v_add_f32 v18, v18, v148
    v_mfma_f32_32x32x16_bf16 v[80:95], v[236:239], v[128:131], v[80:95]
    ds_read_b64_tr_b16 v[236:237], v12 offset:4096
    ds_read_b64_tr_b16 v[238:239], v12 offset:6144
    v_exp_f32 v151, v151
    v_add_f32 v19, v19, v149
    v_cvt_pk_bf16_f32 v145, v146, v147
    v_mfma_f32_32x32x16_bf16 v[96:111], v[240:243], v[128:131], v[96:111]
    ds_read_b64_tr_b16 v[240:241], v9 offset:8192
    ds_read_b64_tr_b16 v[242:243], v9 offset:10240
    v_add_f32 v18, v18, v150
    v_add_f32 v19, v19, v151
    v_cvt_pk_bf16_f32 v146, v148, v149
    v_cvt_pk_bf16_f32 v147, v150, v151
    s_waitcnt lgkmcnt(10)
    v_mfma_f32_32x32x16_bf16 v[112:127], v[244:247], v[128:131], v[112:127]
    ds_read_b64_tr_b16 v[244:245], v10 offset:8192
    ds_read_b64_tr_b16 v[246:247], v10 offset:10240
    v_exp_f32 v152, v152
    v_exp_f32 v153, v153
    s_waitcnt lgkmcnt(10)
    v_mfma_f32_32x32x16_bf16 v[64:79], v[248:251], v[136:139], v[64:79]
    ds_read_b64_tr_b16 v[248:249], v11 offset:8192
    ds_read_b64_tr_b16 v[250:251], v11 offset:10240
    v_exp_f32 v154, v154
    v_exp_f32 v155, v155
    s_waitcnt lgkmcnt(10)
    v_mfma_f32_32x32x16_bf16 v[80:95], v[252:255], v[136:139], v[80:95]
    ds_read_b64_tr_b16 v[252:253], v12 offset:8192
    ds_read_b64_tr_b16 v[254:255], v12 offset:10240
    v_add_f32 v18, v18, v152
    v_add_f32 v19, v19, v153
    v_exp_f32 v156, v156
    s_waitcnt lgkmcnt(10)
    v_mfma_f32_32x32x16_bf16 v[96:111], v[232:235], v[136:139], v[96:111]
    ds_read_b64_tr_b16 v[232:233], v9 offset:12288
    ds_read_b64_tr_b16 v[234:235], v9 offset:14336
    v_add_f32 v18, v18, v154
    v_exp_f32 v157, v157
    v_add_f32 v19, v19, v155
    s_waitcnt lgkmcnt(10)
    v_mfma_f32_32x32x16_bf16 v[112:127], v[236:239], v[136:139], v[112:127]
    ds_read_b64_tr_b16 v[236:237], v10 offset:12288
    ds_read_b64_tr_b16 v[238:239], v10 offset:14336
    v_cvt_pk_bf16_f32 v152, v152, v153
    v_exp_f32 v158, v158
    v_add_f32 v18, v18, v156
    s_waitcnt lgkmcnt(10)
    v_mfma_f32_32x32x16_bf16 v[64:79], v[240:243], v[144:147], v[64:79]
    ds_read_b64_tr_b16 v[240:241], v11 offset:12288
    ds_read_b64_tr_b16 v[242:243], v11 offset:14336
    v_exp_f32 v159, v159
    v_add_f32 v19, v19, v157
    v_cvt_pk_bf16_f32 v153, v154, v155
    s_waitcnt lgkmcnt(10)
    v_mfma_f32_32x32x16_bf16 v[80:95], v[244:247], v[144:147], v[80:95]
    ds_read_b64_tr_b16 v[244:245], v12 offset:12288
    ds_read_b64_tr_b16 v[246:247], v12 offset:14336
    v_add_f32 v18, v18, v158
    v_add_f32 v19, v19, v159
    v_cvt_pk_bf16_f32 v154, v156, v157
    v_cvt_pk_bf16_f32 v155, v158, v159
    s_waitcnt lgkmcnt(10)
    v_mfma_f32_32x32x16_bf16 v[96:111], v[248:251], v[144:147], v[96:111]
    v_max3_f32 v20, v20, v176, v177
    v_max3_f32 v20, v20, v178, v179
    s_waitcnt lgkmcnt(8)
    v_mfma_f32_32x32x16_bf16 v[112:127], v[252:255], v[144:147], v[112:127]
    v_max3_f32 v20, v20, v180, v181
    v_max3_f32 v20, v20, v182, v183
    s_waitcnt lgkmcnt(6)
    v_mfma_f32_32x32x16_bf16 v[64:79], v[232:235], v[152:155], v[64:79]
    v_max3_f32 v20, v20, v184, v185
    v_max3_f32 v20, v20, v186, v187
    s_waitcnt lgkmcnt(4)
    v_mfma_f32_32x32x16_bf16 v[80:95], v[236:239], v[152:155], v[80:95]
    v_max3_f32 v20, v20, v188, v189
    v_max3_f32 v20, v20, v190, v191
    s_waitcnt lgkmcnt(2)
    v_mfma_f32_32x32x16_bf16 v[96:111], v[240:243], v[152:155], v[96:111]
    s_waitcnt lgkmcnt(0)
    v_mfma_f32_32x32x16_bf16 v[112:127], v[244:247], v[152:155], v[112:127]
    v_cmp_lt_f32 vcc, 0x41000000, v20
    s_cbranch_vccnz L_rare_m0
L_ret_m0:
    s_cmp_lg_u32 s43, 0
    s_cbranch_scc1 L_vmskip_1
    s_waitcnt vmcnt(17)
L_vmskip_1:
    s_waitcnt vmcnt(24)
    s_barrier
    ds_read_b128 v[208:211], v1 offset:32768
    ds_read_b128 v[212:215], v2 offset:32768
    ds_read_b128 v[216:219], v3 offset:32768
    ds_read_b128 v[220:223], v4 offset:32768
    ds_read_b128 v[224:227], v5 offset:32768
    ds_read_b128 v[228:231], v6 offset:32768
    v_exp_f32 v160, v160
    v_exp_f32 v161, v161
    v_exp_f32 v162, v162
    v_exp_f32 v163, v163
    s_waitcnt lgkmcnt(5)
    v_mfma_f32_32x32x16_bf16 v[128:143], v[208:211], v[32:35], v[192:207]
    ds_read_b128 v[208:211], v7 offset:32768
    s_add_u32 m0, s46, 16384
    s_nop 0
    buffer_load_dwordx4 v13, s[20:23], s44 offen offset:0 nt lds
    v_add_f32 v18, v18, v160
    v_add_f32 v19, v19, v161
    v_exp_f32 v164, v164
    s_waitcnt lgkmcnt(5)
    v_mfma_f32_32x32x16_bf16 v[128:143], v[212:215], v[36:39], v[128:143]
    ds_read_b128 v[212:215], v8 offset:32768
    s_add_u32 m0, s46, 16384
    s_nop 0
    buffer_load_dwordx4 v14, s[20:23], s44 offen offset:1024 nt lds
    v_add_f32 v18, v18, v162
    v_exp_f32 v165, v165
    v_add_f32 v19, v19, v163
    s_waitcnt lgkmcnt(5)
    v_mfma_f32_32x32x16_bf16 v[128:143], v[216:219], v[40:43], v[128:143]
    ds_read_b128 v[216:219], v1 offset:40960
    s_add_u32 m0, s46, 16384
    s_nop 0
    buffer_load_dwordx4 v15, s[20:23], s44 offen offset:2048 nt lds
    v_cvt_pk_bf16_f32 v160, v160, v161
    v_exp_f32 v166, v166
    v_add_f32 v18, v18, v164
    s_waitcnt lgkmcnt(5)
    v_mfma_f32_32x32x16_bf16 v[128:143], v[220:223], v[44:47], v[128:143]
    ds_read_b128 v[220:223], v2 offset:40960
    s_add_u32 m0, s46, 16384
    s_nop 0
    buffer_load_dwordx4 v16, s[20:23], s44 offen offset:3072 nt lds
    s_add_u32 s44, s44, 0x4000
    v_exp_f32 v167, v167
    v_add_f32 v19, v19, v165
    v_cvt_pk_bf16_f32 v161, v162, v163
    s_waitcnt lgkmcnt(5)
    v_mfma_f32_32x32x16_bf16 v[128:143], v[224:227], v[48:51], v[128:143]
    ds_read_b128 v[224:227], v3 offset:40960
    s_add_u32 m0, s46, 65536
    s_nop 0
    buffer_load_dwordx4 v17, s[24:27], s45 offen offset:0 nt lds
    v_add_f32 v18, v18, v166
    v_add_f32 v19, v19, v167
    v_cvt_pk_bf16_f32 v162, v164, v165
    v_cvt_pk_bf16_f32 v163, v166, v167
    s_waitcnt lgkmcnt(5)
    v_mfma_f32_32x32x16_bf16 v[128:143], v[228:231], v[52:55], v[128:143]
    ds_read_b128 v[228:231], v4 offset:40960
    s_add_u32 m0, s46, 65536
    s_nop 0
    buffer_load_dwordx4 v17, s[24:27], s45 offen offset:1024 nt lds
    v_exp_f32 v168, v168
    v_exp_f32 v169, v169
    s_waitcnt lgkmcnt(5)
    v_mfma_f32_32x32x16_bf16 v[128:143], v[208:211], v[56:59], v[128:143]
    ds_read_b128 v[208:211], v5 offset:40960
    ds_read_b64_tr_b16 v[232:233], v9 offset:16384
    ds_read_b64_tr_b16 v[234:235], v9 offset:18432
    s_add_u32 m0, s46, 65536
    s_nop 0
    buffer_load_dwordx4 v17, s[24:27], s45 offen offset:2048 nt lds
    v_exp_f32 v170, v170
    v_exp_f32 v171, v171
    s_waitcnt lgkmcnt(7)
    v_mfma_f32_32x32x16_bf16 v[128:143], v[212:215], v[60:63], v[128:143]
    ds_read_b128 v[212:215], v6 offset:40960
    ds_read_b64_tr_b16 v[236:237], v10 offset:16384
    ds_read_b64_tr_b16 v[238:239], v10 offset:18432
    s_add_u32 m0, s46, 65536
    s_nop 0
    buffer_load_dwordx4 v17, s[24:27], s45 offen offset:3072 nt lds
    s_add_u32 s45, s45, 0x4000
    v_add_f32 v18, v18, v168
    v_add_f32 v19, v19, v169
    v_exp_f32 v172, v172
    s_waitcnt lgkmcnt(9)
    v_mfma_f32_32x32x16_bf16 v[144:159], v[216:219], v[32:35], v[192:207]
    ds_read_b128 v[216:219], v7 offset:40960
    ds_read_b64_tr_b16 v[240:241], v11 offset:16384
    ds_read_b64_tr_b16 v[242:243], v11 offset:18432
    v_add_f32 v18, v18, v170
    v_exp_f32 v173, v173
    v_add_f32 v19, v19, v171
    s_waitcnt lgkmcnt(11)
    v_mfma_f32_32x32x16_bf16 v[144:159], v[220:223], v[36:39], v[144:159]
    ds_read_b128 v[220:223], v8 offset:40960
    ds_read_b64_tr_b16 v[244:245], v12 offset:16384
    ds_read_b64_tr_b16 v[246:247], v12 offset:18432
    v_cvt_pk_bf16_f32 v168, v168, v169
    v_exp_f32 v174, v174
    v_add_f32 v18, v18, v172
    s_waitcnt lgkmcnt(13)
    v_mfma_f32_32x32x16_bf16 v[144:159], v[224:227], v[40:43], v[144:159]
    ds_read_b64_tr_b16 v[248:249], v9 offset:20480
    ds_read_b64_tr_b16 v[250:251], v9 offset:22528
    v_exp_f32 v175, v175
    v_add_f32 v19, v19, v173
    v_cvt_pk_bf16_f32 v169, v170, v171
    s_waitcnt lgkmcnt(14)
    v_mfma_f32_32x32x16_bf16 v[144:159], v[228:231], v[44:47], v[144:159]
    ds_read_b64_tr_b16 v[252:253], v10 offset:20480
    ds_read_b64_tr_b16 v[254:255], v10 offset:22528
    v_add_f32 v18, v18, v174
    v_add_f32 v19, v19, v175
    v_cvt_pk_bf16_f32 v170, v172, v173
    v_cvt_pk_bf16_f32 v171, v174, v175
    v_max3_f32 v20, v128, v129, v130
    v_max3_f32 v20, v20, v131, v132
    s_waitcnt lgkmcnt(15)
    v_mfma_f32_32x32x16_bf16 v[144:159], v[208:211], v[48:51], v[144:159]
    v_exp_f32 v176, v176
    v_exp_f32 v177, v177
    v_max3_f32 v20, v20, v133, v134
    v_max3_f32 v20, v20, v135, v136
    s_waitcnt lgkmcnt(12)
    v_mfma_f32_32x32x16_bf16 v[144:159], v[212:215], v[52:55], v[144:159]
    v_exp_f32 v178, v178
    v_exp_f32 v179, v179
    v_max3_f32 v20, v20, v137, v138
    v_max3_f32 v20, v20, v139, v140
    s_waitcnt lgkmcnt(9)
    v_mfma_f32_32x32x16_bf16 v[144:159], v[216:219], v[56:59], v[144:159]
    v_add_f32 v18, v18, v176
    v_add_f32 v19, v19, v177
    v_exp_f32 v180, v180
    v_max3_f32 v20, v20, v141, v142
    v_max_f32 v20, v20, v143
    s_waitcnt lgkmcnt(6)
    v_mfma_f32_32x32x16_bf16 v[144:159], v[220:223], v[60:63], v[144:159]
    v_add_f32 v18, v18, v178
    v_exp_f32 v181, v181
    v_add_f32 v19, v19, v179
    v_mfma_f32_32x32x16_bf16 v[64:79], v[232:235], v[160:163], v[64:79]
    ds_read_b64_tr_b16 v[232:233], v11 offset:20480
    ds_read_b64_tr_b16 v[234:235], v11 offset:22528
    v_cvt_pk_bf16_f32 v176, v176, v177
    v_exp_f32 v182, v182
    v_add_f32 v18, v18, v180
    v_mfma_f32_32x32x16_bf16 v[80:95], v[236:239], v[160:163], v[80:95]
    ds_read_b64_tr_b16 v[236:237], v12 offset:20480
    ds_read_b64_tr_b16 v[238:239], v12 offset:22528
    v_exp_f32 v183, v183
    v_add_f32 v19, v19, v181
    v_cvt_pk_bf16_f32 v177, v178, v179
    v_mfma_f32_32x32x16_bf16 v[96:111], v[240:243], v[160:163], v[96:111]
    ds_read_b64_tr_b16 v[240:241], v9 offset:24576
    ds_read_b64_tr_b16 v[242:243], v9 offset:26624
    v_add_f32 v18, v18, v182
    v_add_f32 v19, v19, v183
    v_cvt_pk_bf16_f32 v178, v180, v181
    v_cvt_pk_bf16_f32 v179, v182, v183
    s_waitcnt lgkmcnt(10)
    v_mfma_f32_32x32x16_bf16 v[112:127], v[244:247], v[160:163], v[112:127]
    ds_read_b64_tr_b16 v[244:245], v10 offset:24576
    ds_read_b64_tr_b16 v[246:247], v10 offset:26624
    v_exp_f32 v184, v184
    v_exp_f32 v185, v185
    s_waitcnt lgkmcnt(10)
    v_mfma_f32_32x32x16_bf16 v[64:79], v[248:251], v[168:171], v[64:79]
    ds_read_b64_tr_b16 v[248:249], v11 offset:24576
    ds_read_b64_tr_b16 v[250:251], v11 offset:26624
    v_exp_f32 v186, v186
    v_exp_f32 v187, v187
    s_waitcnt lgkmcnt(10)
    v_mfma_f32_32x32x16_bf16 v[80:95], v[252:255], v[168:171], v[80:95]
    ds_read_b64_tr_b16 v[252:253], v12 offset:24576
    ds_read_b64_tr_b16 v[254:255], v12 offset:26624
    v_add_f32 v18, v18, v184
    v_add_f32 v19, v19, v185
    v_exp_f32 v188, v188
    s_waitcnt lgkmcnt(10)
    v_mfma_f32_32x32x16_bf16 v[96:111], v[232:235], v[168:171], v[96:111]
    ds_read_b64_tr_b16 v[232:233], v9 offset:28672
    ds_read_b64_tr_b16 v[234:235], v9 offset:30720
    v_add_f32 v18, v18, v186
    v_exp_f32 v189, v189
    v_add_f32 v19, v19, v187
    s_waitcnt lgkmcnt(10)
    v_mfma_f32_32x32x16_bf16 v[112:127], v[236:239], v[168:171], v[112:127]
    ds_read_b64_tr_b16 v[236:237], v10 offset:28672
    ds_read_b64_tr_b16 v[238:239], v10 offset:30720
    v_cvt_pk_bf16_f32 v184, v184, v185
    v_exp_f32 v190, v190
    v_add_f32 v18, v18, v188
    s_waitcnt lgkmcnt(10)
    v_mfma_f32_32x32x16_bf16 v[64:79], v[240:243], v[176:179], v[64:79]
    ds_read_b64_tr_b16 v[240:241], v11 offset:28672
    ds_read_b64_tr_b16 v[242:243], v11 offset:30720
    v_exp_f32 v191, v191
    v_add_f32 v19, v19, v189
    v_cvt_pk_bf16_f32 v185, v186, v187
    s_waitcnt lgkmcnt(10)
    v_mfma_f32_32x32x16_bf16 v[80:95], v[244:247], v[176:179], v[80:95]
    ds_read_b64_tr_b16 v[244:245], v12 offset:28672
    ds_read_b64_tr_b16 v[246:247], v12 offset:30720
    v_add_f32 v18, v18, v190
    v_add_f32 v19, v19, v191
    v_cvt_pk_bf16_f32 v186, v188, v189
    v_cvt_pk_bf16_f32 v187, v190, v191
    s_waitcnt lgkmcnt(10)
    v_mfma_f32_32x32x16_bf16 v[96:111], v[248:251], v[176:179], v[96:111]
    v_max3_f32 v20, v20, v144, v145
    v_max3_f32 v20, v20, v146, v147
    s_waitcnt lgkmcnt(8)
    v_mfma_f32_32x32x16_bf16 v[112:127], v[252:255], v[176:179], v[112:127]
    v_max3_f32 v20, v20, v148, v149
    v_max3_f32 v20, v20, v150, v151
    s_waitcnt lgkmcnt(6)
    v_mfma_f32_32x32x16_bf16 v[64:79], v[232:235], v[184:187], v[64:79]
    v_max3_f32 v20, v20, v152, v153
    v_max3_f32 v20, v20, v154, v155
    s_waitcnt lgkmcnt(4)
    v_mfma_f32_32x32x16_bf16 v[80:95], v[236:239], v[184:187], v[80:95]
    v_max3_f32 v20, v20, v156, v157
    v_max3_f32 v20, v20, v158, v159
    s_waitcnt lgkmcnt(2)
    v_mfma_f32_32x32x16_bf16 v[96:111], v[240:243], v[184:187], v[96:111]
    s_waitcnt lgkmcnt(0)
    v_mfma_f32_32x32x16_bf16 v[112:127], v[244:247], v[184:187], v[112:127]
    v_cmp_lt_f32 vcc, 0x41000000, v20
    s_cbranch_vccnz L_rare_m1
L_ret_m1:
    s_waitcnt vmcnt(16)
    s_barrier
    v_readfirstlane_b32 s47, v26
    s_cmp_lt_u32 s47, 256
    s_cbranch_scc1 L_cnt
L_cnt_ok:
    s_cmp_eq_u32 s43, 1
    s_cbranch_scc1 L_wrd_0
    s_cmp_eq_u32 s43, 2
    s_cbranch_scc1 L_wrd_1
    s_cmp_eq_u32 s43, 3
    s_cbranch_scc1 L_wrd_2
    s_cmp_eq_u32 s43, 4
    s_cbranch_scc1 L_wrd_3
    s_cmp_eq_u32 s43, 5
    s_cbranch_scc1 L_wrd_4
    s_cmp_eq_u32 s43, 6
    s_cbranch_scc1 L_wrd_5
L_wrd_ret:
    ds_read_b128 v[208:211], v1 offset:49152
    ds_read_b128 v[212:215], v2 offset:49152
    ds_read_b128 v[216:219], v3 offset:49152
    ds_read_b128 v[220:223], v4 offset:49152
    ds_read_b128 v[224:227], v5 offset:49152
    ds_read_b128 v[228:231], v6 offset:49152
    s_lshr_b32 s48, s43, 1
    s_add_u32 s48, s48, s54
    s_and_b32 s48, s48, 7
    s_lshl_b32 s48, s48, 1
    s_and_b32 s47, s43, 1
    s_add_u32 s48, s48, s47
    s_lshl_b32 s48, s48, 13
    v_exp_f32 v128, v128
    v_exp_f32 v129, v129
    v_exp_f32 v130, v130
    v_exp_f32 v131, v131
    s_waitcnt lgkmcnt(5)
    v_mfma_f32_32x32x16_bf16 v[160:175], v[208:211], v[32:35], v[192:207]
    ds_read_b128 v[208:211], v7 offset:49152
    s_add_u32 m0, s46, 32768
    s_nop 0
    buffer_load_dwordx4 v13, s[20:23], s44 offen offset:0 nt lds
    v_add_f32 v18, v18, v128
    v_add_f32 v19, v19, v129
    v_exp_f32 v132, v132
    s_waitcnt lgkmcnt(5)
    v_mfma_f32_32x32x16_bf16 v[160:175], v[212:215], v[36:39], v[160:175]
    ds_read_b128 v[212:215], v8 offset:49152
    s_add_u32 m0, s46, 32768
    s_nop 0
    buffer_load_dwordx4 v14, s[20:23], s44 offen offset:1024 nt lds
    v_add_f32 v18, v18, v130
    v_exp_f32 v133, v133
    v_add_f32 v19, v19, v131
    s_waitcnt lgkmcnt(5)
    v_mfma_f32_32x32x16_bf16 v[160:175], v[216:219], v[40:43], v[160:175]
    ds_read_b128 v[216:219], v1 offset:57344
    s_add_u32 m0, s46, 32768
    s_nop 0
    buffer_load_dwordx4 v15, s[20:23], s44 offen offset:2048 nt lds
    v_cvt_pk_bf16_f32 v128, v128, v129
    v_exp_f32 v134, v134
    v_add_f32 v18, v18, v132
    s_waitcnt lgkmcnt(5)
    v_mfma_f32_32x32x16_bf16 v[160:175], v[220:223], v[44:47], v[160:175]
    ds_read_b128 v[220:223], v2 offset:57344
    s_add_u32 m0, s46, 32768
    s_nop 0
    buffer_load_dwordx4 v16, s[20:23], s44 offen offset:3072 nt lds
    s_add_u32 s44, s44, 0x4000
    v_exp_f32 v135, v135
    v_add_f32 v19, v19, v133
    v_cvt_pk_bf16_f32 v129, v130, v131
    s_waitcnt lgkmcnt(5)
    v_mfma_f32_32x32x16_bf16 v[160:175], v[224:227], v[48:51], v[160:175]
    ds_read_b128 v[224:227], v3 offset:57344
    s_add_u32 m0, s46, 81920
    s_nop 0
    buffer_load_dwordx4 v17, s[24:27], s45 offen offset:0 nt lds
    v_add_f32 v18, v18, v134
    v_add_f32 v19, v19, v135
    v_cvt_pk_bf16_f32 v130, v132, v133
    v_cvt_pk_bf16_f32 v131, v134, v135
    s_waitcnt lgkmcnt(5)
    v_mfma_f32_32x32x16_bf16 v[160:175], v[228:231], v[52:55], v[160:175]
    ds_read_b128 v[228:231], v4 offset:57344
    s_add_u32 m0, s46, 81920
    s_nop 0
    buffer_load_dwordx4 v17, s[24:27], s45 offen offset:1024 nt lds
    v_exp_f32 v136, v136
    v_exp_f32 v137, v137
    s_waitcnt lgkmcnt(5)
    v_mfma_f32_32x32x16_bf16 v[160:175], v[208:211], v[56:59], v[160:175]
    ds_read_b128 v[208:211], v5 offset:57344
    ds_read_b64_tr_b16 v[232:233], v9 offset:32768
    ds_read_b64_tr_b16 v[234:235], v9 offset:34816
    s_add_u32 m0, s46, 81920
    s_nop 0
    buffer_load_dwordx4 v17, s[24:27], s45 offen offset:2048 nt lds
    v_exp_f32 v138, v138
    v_exp_f32 v139, v139
    s_waitcnt lgkmcnt(7)
    v_mfma_f32_32x32x16_bf16 v[160:175], v[212:215], v[60:63], v[160:175]
    ds_read_b128 v[212:215], v6 offset:57344
    ds_read_b64_tr_b16 v[236:237], v10 offset:32768
    ds_read_b64_tr_b16 v[238:239], v10 offset:34816
    s_add_u32 m0, s46, 81920
    s_nop 0
    buffer_load_dwordx4 v17, s[24:27], s45 offen offset:3072 nt lds
    s_add_u32 s45, s45, 0x4000
    v_add_f32 v18, v18, v136
    v_add_f32 v19, v19, v137
    v_exp_f32 v140, v140
    s_waitcnt lgkmcnt(9)
    v_mfma_f32_32x32x16_bf16 v[176:191], v[216:219], v[32:35], v[192:207]
    ds_read_b128 v[216:219], v7 offset:57344
    ds_read_b64_tr_b16 v[240:241], v11 offset:32768
    ds_read_b64_tr_b16 v[242:243], v11 offset:34816
    s_add_u32 m0, s57, 0
    s_add_u32 s47, s48, 0x0
    buffer_load_dwordx4 v27, s[64:67], s47 offen offset:0 sc1 lds
    v_add_f32 v18, v18, v138
    v_exp_f32 v141, v141
    v_add_f32 v19, v19, v139
    s_waitcnt lgkmcnt(11)
    v_mfma_f32_32x32x16_bf16 v[176:191], v[220:223], v[36:39], v[176:191]
    ds_read_b128 v[220:223], v8 offset:57344
    ds_read_b64_tr_b16 v[244:245], v12 offset:32768
    ds_read_b64_tr_b16 v[246:247], v12 offset:34816
    v_cvt_pk_bf16_f32 v136, v136, v137
    v_exp_f32 v142, v142
    v_add_f32 v18, v18, v140
    s_waitcnt lgkmcnt(13)
    v_mfma_f32_32x32x16_bf16 v[176:191], v[224:227], v[40:43], v[176:191]
    ds_read_b64_tr_b16 v[248:249], v9 offset:36864
    ds_read_b64_tr_b16 v[250:251], v9 offset:38912
    s_add_u32 m0, s57, 0
    s_add_u32 s47, s48, 0x0
    buffer_load_dwordx4 v27, s[64:67], s47 offen offset:1024 sc1 lds
    v_exp_f32 v143, v143
    v_add_f32 v19, v19, v141
    v_cvt_pk_bf16_f32 v137, v138, v139
    s_waitcnt lgkmcnt(14)
    v_mfma_f32_32x32x16_bf16 v[176:191], v[228:231], v[44:47], v[176:191]
    ds_read_b64_tr_b16 v[252:253], v10 offset:36864
    ds_read_b64_tr_b16 v[254:255], v10 offset:38912
    v_add_f32 v18, v18, v142
    v_add_f32 v19, v19, v143
    v_cvt_pk_bf16_f32 v138, v140, v141
    v_cvt_pk_bf16_f32 v139, v142, v143
    v_max3_f32 v20, v160, v161, v162
    v_max3_f32 v20, v20, v163, v164
    s_waitcnt lgkmcnt(15)
    v_mfma_f32_32x32x16_bf16 v[176:191], v[208:211], v[48:51], v[176:191]
    s_add_u32 m0, s57, 0
    s_add_u32 s47, s48, 0x0
    buffer_load_dwordx4 v27, s[64:67], s47 offen offset:2048 sc1 lds
    v_exp_f32 v144, v144
    v_exp_f32 v145, v145
    v_max3_f32 v20, v20, v165, v166
    v_max3_f32 v20, v20, v167, v168
    s_waitcnt lgkmcnt(12)
    v_mfma_f32_32x32x16_bf16 v[176:191], v[212:215], v[52:55], v[176:191]
    v_exp_f32 v146, v146
    v_exp_f32 v147, v147
    v_max3_f32 v20, v20, v169, v170
    v_max3_f32 v20, v20, v171, v172
    s_waitcnt lgkmcnt(9)
    v_mfma_f32_32x32x16_bf16 v[176:191], v[216:219], v[56:59], v[176:191]
    s_add_u32 m0, s57, 0
    s_add_u32 s47, s48, 0x0
    buffer_load_dwordx4 v27, s[64:67], s47 offen offset:3072 sc1 lds
    v_add_f32 v18, v18, v144
    v_add_f32 v19, v19, v145
    v_exp_f32 v148, v148
    v_max3_f32 v20, v20, v173, v174
    v_max_f32 v20, v20, v175
    s_waitcnt lgkmcnt(6)
    v_mfma_f32_32x32x16_bf16 v[176:191], v[220:223], v[60:63], v[176:191]
    v_add_f32 v18, v18, v146
    v_exp_f32 v149, v149
    v_add_f32 v19, v19, v147
    v_mfma_f32_32x32x16_bf16 v[64:79], v[232:235], v[128:131], v[64:79]
    ds_read_b64_tr_b16 v[232:233], v11 offset:36864
    ds_read_b64_tr_b16 v[234:235], v11 offset:38912
    s_add_u32 m0, s57, 4096
    s_add_u32 s47, s48, 0x1000
    buffer_load_dwordx4 v27, s[64:67], s47 offen offset:0 sc1 lds
    v_cvt_pk_bf16_f32 v144, v144, v145
    v_exp_f32 v150, v150
    v_add_f32 v18, v18, v148
    v_mfma_f32_32x32x16_bf16 v[80:95], v[236:239], v[128:131], v[80:95]
    ds_read_b64_tr_b16 v[236:237], v12 offset:36864
    ds_read_b64_tr_b16 v[238:239], v12 offset:38912
    v_exp_f32 v151, v151
    v_add_f32 v19, v19, v149
    v_cvt_pk_bf16_f32 v145, v146, v147
    v_mfma_f32_32x32x16_bf16 v[96:111], v[240:243], v[128:131], v[96:111]
    ds_read_b64_tr_b16 v[240:241], v9 offset:40960
    ds_read_b64_tr_b16 v[242:243], v9 offset:43008
    s_add_u32 m0, s57, 4096
    s_add_u32 s47, s48, 0x1000
    buffer_load_dwordx4 v27, s[64:67], s47 offen offset:1024 sc1 lds
    v_add_f32 v18, v18, v150
    v_add_f32 v19, v19, v151
    v_cvt_pk_bf16_f32 v146, v148, v149
    v_cvt_pk_bf16_f32 v147, v150, v151
    s_waitcnt lgkmcnt(10)
    v_mfma_f32_32x32x16_bf16 v[112:127], v[244:247], v[128:131], v[112:127]
    ds_read_b64_tr_b16 v[244:245], v10 offset:40960
    ds_read_b64_tr_b16 v[246:247], v10 offset:43008
    v_exp_f32 v152, v152
    v_exp_f32 v153, v153
    s_waitcnt lgkmcnt(10)
    v_mfma_f32_32x32x16_bf16 v[64:79], v[248:251], v[136:139], v[64:79]
    ds_read_b64_tr_b16 v[248:249], v11 offset:40960
    ds_read_b64_tr_b16 v[250:251], v11 offset:43008
    s_add_u32 m0, s57, 4096
    s_add_u32 s47, s48, 0x1000
    buffer_load_dwordx4 v27, s[64:67], s47 offen offset:2048 sc1 lds
    v_exp_f32 v154, v154
    v_exp_f32 v155, v155
    s_waitcnt lgkmcnt(10)
    v_mfma_f32_32x32x16_bf16 v[80:95], v[252:255], v[136:139], v[80:95]
    ds_read_b64_tr_b16 v[252:253], v12 offset:40960
    ds_read_b64_tr_b16 v[254:255], v12 offset:43008
    v_add_f32 v18, v18, v152
    v_add_f32 v19, v19, v153
    v_exp_f32 v156, v156
    s_waitcnt lgkmcnt(10)
    v_mfma_f32_32x32x16_bf16 v[96:111], v[232:235], v[136:139], v[96:111]
    ds_read_b64_tr_b16 v[232:233], v9 offset:45056
    ds_read_b64_tr_b16 v[234:235], v9 offset:47104
    s_add_u32 m0, s57, 4096
    s_add_u32 s47, s48, 0x1000
    buffer_load_dwordx4 v27, s[64:67], s47 offen offset:3072 sc1 lds
    v_add_f32 v18, v18, v154
    v_exp_f32 v157, v157
    v_add_f32 v19, v19, v155
    s_waitcnt lgkmcnt(10)
    v_mfma_f32_32x32x16_bf16 v[112:127], v[236:239], v[136:139], v[112:127]
    ds_read_b64_tr_b16 v[236:237], v10 offset:45056
    ds_read_b64_tr_b16 v[238:239], v10 offset:47104
    v_cvt_pk_bf16_f32 v152, v152, v153
    v_exp_f32 v158, v158
    v_add_f32 v18, v18, v156
    s_waitcnt lgkmcnt(10)
    v_mfma_f32_32x32x16_bf16 v[64:79], v[240:243], v[144:147], v[64:79]
    ds_read_b64_tr_b16 v[240:241], v11 offset:45056
    ds_read_b64_tr_b16 v[242:243], v11 offset:47104
    v_exp_f32 v159, v159
    v_add_f32 v19, v19, v157
    v_cvt_pk_bf16_f32 v153, v154, v155
    s_waitcnt lgkmcnt(10)
    v_mfma_f32_32x32x16_bf16 v[80:95], v[244:247], v[144:147], v[80:95]
    ds_read_b64_tr_b16 v[244:245], v12 offset:45056
    ds_read_b64_tr_b16 v[246:247], v12 offset:47104
    v_add_f32 v18, v18, v158
    v_add_f32 v19, v19, v159
    v_cvt_pk_bf16_f32 v154, v156, v157
    v_cvt_pk_bf16_f32 v155, v158, v159
    s_waitcnt lgkmcnt(10)
    v_mfma_f32_32x32x16_bf16 v[96:111], v[248:251], v[144:147], v[96:111]
    v_max3_f32 v20, v20, v176, v177
    v_max3_f32 v20, v20, v178, v179
    s_waitcnt lgkmcnt(8)
    v_mfma_f32_32x32x16_bf16 v[112:127], v[252:255], v[144:147], v[112:127]
    v_max3_f32 v20, v20, v180, v181
    v_max3_f32 v20, v20, v182, v183
    s_waitcnt lgkmcnt(6)
    v_mfma_f32_32x32x16_bf16 v[64:79], v[232:235], v[152:155], v[64:79]
    v_max3_f32 v20, v20, v184, v185
    v_max3_f32 v20, v20, v186, v187
    s_waitcnt lgkmcnt(4)
    v_mfma_f32_32x32x16_bf16 v[80:95], v[236:239], v[152:155], v[80:95]
    v_max3_f32 v20, v20, v188, v189
    v_max3_f32 v20, v20, v190, v191
    s_waitcnt lgkmcnt(2)
    v_mfma_f32_32x32x16_bf16 v[96:111], v[240:243], v[152:155], v[96:111]
    s_waitcnt lgkmcnt(0)
    v_mfma_f32_32x32x16_bf16 v[112:127], v[244:247], v[152:155], v[112:127]
    v_cmp_lt_f32 vcc, 0x41000000, v20
    s_cbranch_vccnz L_rare_m2
L_ret_m2:
    s_waitcnt vmcnt(24)
    s_barrier
    ds_read_b128 v[208:211], v1 offset:0
    ds_read_b128 v[212:215], v2 offset:0
    ds_read_b128 v[216:219], v3 offset:0
    ds_read_b128 v[220:223], v4 offset:0
    ds_read_b128 v[224:227], v5 offset:0
    ds_read_b128 v[228:231], v6 offset:0
    v_exp_f32 v160, v160
    v_exp_f32 v161, v161
    v_exp_f32 v162, v162
    v_exp_f32 v163, v163
    s_waitcnt lgkmcnt(5)
    v_mfma_f32_32x32x16_bf16 v[128:143], v[208:211], v[32:35], v[192:207]
    ds_read_b128 v[208:211], v7 offset:0
    s_add_u32 m0, s46, 49152
    s_nop 0
    buffer_load_dwordx4 v13, s[20:23], s44 offen offset:0 nt lds
    v_add_f32 v18, v18, v160
    v_add_f32 v19, v19, v161
    v_exp_f32 v164, v164
    s_waitcnt lgkmcnt(5)
    v_mfma_f32_32x32x16_bf16 v[128:143], v[212:215], v[36:39], v[128:143]
    ds_read_b128 v[212:215], v8 offset:0
    s_add_u32 m0, s46, 49152
    s_nop 0
    buffer_load_dwordx4 v14, s[20:23], s44 offen offset:1024 nt lds
    v_add_f32 v18, v18, v162
    v_exp_f32 v165, v165
    v_add_f32 v19, v19, v163
    s_waitcnt lgkmcnt(5)
    v_mfma_f32_32x32x16_bf16 v[128:143], v[216:219], v[40:43], v[128:143]
    ds_read_b128 v[216:219], v1 offset:8192
    s_add_u32 m0, s46, 49152
    s_nop 0
    buffer_load_dwordx4 v15, s[20:23], s44 offen offset:2048 nt lds
    v_cvt_pk_bf16_f32 v160, v160, v161
    v_exp_f32 v166, v166
    v_add_f32 v18, v18, v164
    s_waitcnt lgkmcnt(5)
    v_mfma_f32_32x32x16_bf16 v[128:143], v[220:223], v[44:47], v[128:143]
    ds_read_b128 v[220:223], v2 offset:8192
    s_add_u32 m0, s46, 49152
    s_nop 0
    buffer_load_dwordx4 v16, s[20:23], s44 offen offset:3072 nt lds
    s_add_u32 s44, s44, 0x4000
    v_exp_f32 v167, v167
    v_add_f32 v19, v19, v165
    v_cvt_pk_bf16_f32 v161, v162, v163
    s_waitcnt lgkmcnt(5)
    v_mfma_f32_32x32x16_bf16 v[128:143], v[224:227], v[48:51], v[128:143]
    ds_read_b128 v[224:227], v3 offset:8192
    s_add_u32 m0, s46, 98304
    s_nop 0
    buffer_load_dwordx4 v17, s[24:27], s45 offen offset:0 nt lds
    v_add_f32 v18, v18, v166
    v_add_f32 v19, v19, v167
    v_cvt_pk_bf16_f32 v162, v164, v165
    v_cvt_pk_bf16_f32 v163, v166, v167
    s_waitcnt lgkmcnt(5)
    v_mfma_f32_32x32x16_bf16 v[128:143], v[228:231], v[52:55], v[128:143]
    ds_read_b128 v[228:231], v4 offset:8192
    s_add_u32 m0, s46, 98304
    s_nop 0
    buffer_load_dwordx4 v17, s[24:27], s45 offen offset:1024 nt lds
    v_exp_f32 v168, v168
    v_exp_f32 v169, v169
    s_waitcnt lgkmcnt(5)
    v_mfma_f32_32x32x16_bf16 v[128:143], v[208:211], v[56:59], v[128:143]
    ds_read_b128 v[208:211], v5 offset:8192
    ds_read_b64_tr_b16 v[232:233], v9 offset:49152
    ds_read_b64_tr_b16 v[234:235], v9 offset:51200
    s_add_u32 m0, s46, 98304
    s_nop 0
    buffer_load_dwordx4 v17, s[24:27], s45 offen offset:2048 nt lds
    v_exp_f32 v170, v170
    v_exp_f32 v171, v171
    s_waitcnt lgkmcnt(7)
    v_mfma_f32_32x32x16_bf16 v[128:143], v[212:215], v[60:63], v[128:143]
    ds_read_b128 v[212:215], v6 offset:8192
    ds_read_b64_tr_b16 v[236:237], v10 offset:49152
    ds_read_b64_tr_b16 v[238:239], v10 offset:51200
    s_add_u32 m0, s46, 98304
    s_nop 0
    buffer_load_dwordx4 v17, s[24:27], s45 offen offset:3072 nt lds
    s_add_u32 s45, s45, 0x4000
    v_add_f32 v18, v18, v168
    v_add_f32 v19, v19, v169
    v_exp_f32 v172, v172
    s_waitcnt lgkmcnt(9)
    v_mfma_f32_32x32x16_bf16 v[144:159], v[216:219], v[32:35], v[192:207]
    ds_read_b128 v[216:219], v7 offset:8192
    ds_read_b64_tr_b16 v[240:241], v11 offset:49152
    ds_read_b64_tr_b16 v[242:243], v11 offset:51200
    v_add_f32 v18, v18, v170
    v_exp_f32 v173, v173
    v_add_f32 v19, v19, v171
    s_waitcnt lgkmcnt(11)
    v_mfma_f32_32x32x16_bf16 v[144:159], v[220:223], v[36:39], v[144:159]
    ds_read_b128 v[220:223], v8 offset:8192
    ds_read_b64_tr_b16 v[244:245], v12 offset:49152
    ds_read_b64_tr_b16 v[246:247], v12 offset:51200
    v_cvt_pk_bf16_f32 v168, v168, v169
    v_exp_f32 v174, v174
    v_add_f32 v18, v18, v172
    s_waitcnt lgkmcnt(13)
    v_mfma_f32_32x32x16_bf16 v[144:159], v[224:227], v[40:43], v[144:159]
    ds_read_b64_tr_b16 v[248:249], v9 offset:53248
    ds_read_b64_tr_b16 v[250:251], v9 offset:55296
    v_exp_f32 v175, v175
    v_add_f32 v19, v19, v173
    v_cvt_pk_bf16_f32 v169, v170, v171
    s_waitcnt lgkmcnt(14)
    v_mfma_f32_32x32x16_bf16 v[144:159], v[228:231], v[44:47], v[144:159]
    ds_read_b64_tr_b16 v[252:253], v10 offset:53248
    ds_read_b64_tr_b16 v[254:255], v10 offset:55296
    v_add_f32 v18, v18, v174
    v_add_f32 v19, v19, v175
    v_cvt_pk_bf16_f32 v170, v172, v173
    v_cvt_pk_bf16_f32 v171, v174, v175
    v_max3_f32 v20, v128, v129, v130
    v_max3_f32 v20, v20, v131, v132
    s_waitcnt lgkmcnt(15)
    v_mfma_f32_32x32x16_bf16 v[144:159], v[208:211], v[48:51], v[144:159]
    v_exp_f32 v176, v176
    v_exp_f32 v177, v177
    v_max3_f32 v20, v20, v133, v134
    v_max3_f32 v20, v20, v135, v136
    s_waitcnt lgkmcnt(12)
    v_mfma_f32_32x32x16_bf16 v[144:159], v[212:215], v[52:55], v[144:159]
    v_exp_f32 v178, v178
    v_exp_f32 v179, v179
    v_max3_f32 v20, v20, v137, v138
    v_max3_f32 v20, v20, v139, v140
    s_waitcnt lgkmcnt(9)
    v_mfma_f32_32x32x16_bf16 v[144:159], v[216:219], v[56:59], v[144:159]
    v_add_f32 v18, v18, v176
    v_add_f32 v19, v19, v177
    v_exp_f32 v180, v180
    v_max3_f32 v20, v20, v141, v142
    v_max_f32 v20, v20, v143
    s_waitcnt lgkmcnt(6)
    v_mfma_f32_32x32x16_bf16 v[144:159], v[220:223], v[60:63], v[144:159]
    v_add_f32 v18, v18, v178
    v_exp_f32 v181, v181
    v_add_f32 v19, v19, v179
    v_mfma_f32_32x32x16_bf16 v[64:79], v[232:235], v[160:163], v[64:79]
    ds_read_b64_tr_b16 v[232:233], v11 offset:53248
    ds_read_b64_tr_b16 v[234:235], v11 offset:55296
    v_cvt_pk_bf16_f32 v176, v176, v177
    v_exp_f32 v182, v182
    v_add_f32 v18, v18, v180
    v_mfma_f32_32x32x16_bf16 v[80:95], v[236:239], v[160:163], v[80:95]
    ds_read_b64_tr_b16 v[236:237], v12 offset:53248
    ds_read_b64_tr_b16 v[238:239], v12 offset:55296
    v_exp_f32 v183, v183
    v_add_f32 v19, v19, v181
    v_cvt_pk_bf16_f32 v177, v178, v179
    v_mfma_f32_32x32x16_bf16 v[96:111], v[240:243], v[160:163], v[96:111]
    ds_read_b64_tr_b16 v[240:241], v9 offset:57344
    ds_read_b64_tr_b16 v[242:243], v9 offset:59392
    v_add_f32 v18, v18, v182
    v_add_f32 v19, v19, v183
    v_cvt_pk_bf16_f32 v178, v180, v181
    v_cvt_pk_bf16_f32 v179, v182, v183
    s_waitcnt lgkmcnt(10)
    v_mfma_f32_32x32x16_bf16 v[112:127], v[244:247], v[160:163], v[112:127]
    ds_read_b64_tr_b16 v[244:245], v10 offset:57344
    ds_read_b64_tr_b16 v[246:247], v10 offset:59392
    v_exp_f32 v184, v184
    v_exp_f32 v185, v185
    s_waitcnt lgkmcnt(10)
    v_mfma_f32_32x32x16_bf16 v[64:79], v[248:251], v[168:171], v[64:79]
    ds_read_b64_tr_b16 v[248:249], v11 offset:57344
    ds_read_b64_tr_b16 v[250:251], v11 offset:59392
    v_exp_f32 v186, v186
    v_exp_f32 v187, v187
    s_waitcnt lgkmcnt(10)
    v_mfma_f32_32x32x16_bf16 v[80:95], v[252:255], v[168:171], v[80:95]
    ds_read_b64_tr_b16 v[252:253], v12 offset:57344
    ds_read_b64_tr_b16 v[254:255], v12 offset:59392
    v_add_f32 v18, v18, v184
    v_add_f32 v19, v19, v185
    v_exp_f32 v188, v188
    s_waitcnt lgkmcnt(10)
    v_mfma_f32_32x32x16_bf16 v[96:111], v[232:235], v[168:171], v[96:111]
    ds_read_b64_tr_b16 v[232:233], v9 offset:61440
    ds_read_b64_tr_b16 v[234:235], v9 offset:63488
    v_add_f32 v18, v18, v186
    v_exp_f32 v189, v189
    v_add_f32 v19, v19, v187
    s_waitcnt lgkmcnt(10)
    v_mfma_f32_32x32x16_bf16 v[112:127], v[236:239], v[168:171], v[112:127]
    ds_read_b64_tr_b16 v[236:237], v10 offset:61440
    ds_read_b64_tr_b16 v[238:239], v10 offset:63488
    v_cvt_pk_bf16_f32 v184, v184, v185
    v_exp_f32 v190, v190
    v_add_f32 v18, v18, v188
    s_waitcnt lgkmcnt(10)
    v_mfma_f32_32x32x16_bf16 v[64:79], v[240:243], v[176:179], v[64:79]
    ds_read_b64_tr_b16 v[240:241], v11 offset:61440
    ds_read_b64_tr_b16 v[242:243], v11 offset:63488
    v_exp_f32 v191, v191
    v_add_f32 v19, v19, v189
    v_cvt_pk_bf16_f32 v185, v186, v187
    s_waitcnt lgkmcnt(10)
    v_mfma_f32_32x32x16_bf16 v[80:95], v[244:247], v[176:179], v[80:95]
    ds_read_b64_tr_b16 v[244:245], v12 offset:61440
    ds_read_b64_tr_b16 v[246:247], v12 offset:63488
    v_add_f32 v18, v18, v190
    v_add_f32 v19, v19, v191
    v_cvt_pk_bf16_f32 v186, v188, v189
    v_cvt_pk_bf16_f32 v187, v190, v191
    s_waitcnt lgkmcnt(10)
    v_mfma_f32_32x32x16_bf16 v[96:111], v[248:251], v[176:179], v[96:111]
    v_max3_f32 v20, v20, v144, v145
    v_max3_f32 v20, v20, v146, v147
    s_waitcnt lgkmcnt(8)
    v_mfma_f32_32x32x16_bf16 v[112:127], v[252:255], v[176:179], v[112:127]
    v_max3_f32 v20, v20, v148, v149
    v_max3_f32 v20, v20, v150, v151
    s_waitcnt lgkmcnt(6)
    v_mfma_f32_32x32x16_bf16 v[64:79], v[232:235], v[184:187], v[64:79]
    v_max3_f32 v20, v20, v152, v153
    v_max3_f32 v20, v20, v154, v155
    s_waitcnt lgkmcnt(4)
    v_mfma_f32_32x32x16_bf16 v[80:95], v[236:239], v[184:187], v[80:95]
    v_max3_f32 v20, v20, v156, v157
    v_max3_f32 v20, v20, v158, v159
    s_waitcnt lgkmcnt(2)
    v_mfma_f32_32x32x16_bf16 v[96:111], v[240:243], v[184:187], v[96:111]
    s_waitcnt lgkmcnt(0)
    v_mfma_f32_32x32x16_bf16 v[112:127], v[244:247], v[184:187], v[112:127]
    v_cmp_lt_f32 vcc, 0x41000000, v20
    s_cbranch_vccnz L_rare_m3
L_ret_m3:
    s_add_u32 s43, s43, 1
    s_cmp_lt_u32 s43, 7
    s_cbranch_scc1 L_loop
    s_waitcnt vmcnt(24)
    s_barrier
    ds_read_b128 v[208:211], v1 offset:16384
    ds_read_b128 v[212:215], v2 offset:16384
    ds_read_b128 v[216:219], v3 offset:16384
    ds_read_b128 v[220:223], v4 offset:16384
    ds_read_b128 v[224:227], v5 offset:16384
    ds_read_b128 v[228:231], v6 offset:16384
    v_exp_f32 v128, v128
    v_exp_f32 v129, v129
    v_exp_f32 v130, v130
    v_exp_f32 v131, v131
    s_waitcnt lgkmcnt(5)
    v_mfma_f32_32x32x16_bf16 v[160:175], v[208:211], v[32:35], v[192:207]
    ds_read_b128 v[208:211], v7 offset:16384
    s_add_u32 m0, s46, 114688
    s_nop 0
    buffer_load_dwordx4 v17, s[24:27], s45 offen offset:0 nt lds
    v_add_f32 v18, v18, v128
    v_add_f32 v19, v19, v129
    v_exp_f32 v132, v132
    s_waitcnt lgkmcnt(5)
    v_mfma_f32_32x32x16_bf16 v[160:175], v[212:215], v[36:39], v[160:175]
    ds_read_b128 v[212:215], v8 offset:16384
    s_add_u32 m0, s46, 114688
    s_nop 0
    buffer_load_dwordx4 v17, s[24:27], s45 offen offset:1024 nt lds
    v_add_f32 v18, v18, v130
    v_exp_f32 v133, v133
    v_add_f32 v19, v19, v131
    s_waitcnt lgkmcnt(5)
    v_mfma_f32_32x32x16_bf16 v[160:175], v[216:219], v[40:43], v[160:175]
    ds_read_b128 v[216:219], v1 offset:24576
    s_add_u32 m0, s46, 114688
    s_nop 0
    buffer_load_dwordx4 v17, s[24:27], s45 offen offset:2048 nt lds
    v_cvt_pk_bf16_f32 v128, v128, v129
    v_exp_f32 v134, v134
    v_add_f32 v18, v18, v132
    s_waitcnt lgkmcnt(5)
    v_mfma_f32_32x32x16_bf16 v[160:175], v[220:223], v[44:47], v[160:175]
    ds_read_b128 v[220:223], v2 offset:24576
    s_add_u32 m0, s46, 114688
    s_nop 0
    buffer_load_dwordx4 v17, s[24:27], s45 offen offset:3072 nt lds
    s_add_u32 s45, s45, 0x4000
    v_exp_f32 v135, v135
    v_add_f32 v19, v19, v133
    v_cvt_pk_bf16_f32 v129, v130, v131
    s_waitcnt lgkmcnt(5)
    v_mfma_f32_32x32x16_bf16 v[160:175], v[224:227], v[48:51], v[160:175]
    ds_read_b128 v[224:227], v3 offset:24576
    s_add_u32 m0, s46, 0
    s_add_u32 s47, s88, 0x0
    buffer_load_dwordx4 v27, s[64:67], s47 offen offset:0 sc1 lds
    v_add_f32 v18, v18, v134
    v_add_f32 v19, v19, v135
    v_cvt_pk_bf16_f32 v130, v132, v133
    v_cvt_pk_bf16_f32 v131, v134, v135
    s_waitcnt lgkmcnt(5)
    v_mfma_f32_32x32x16_bf16 v[160:175], v[228:231], v[52:55], v[160:175]
    ds_read_b128 v[228:231], v4 offset:24576
    v_exp_f32 v136, v136
    v_exp_f32 v137, v137
    s_waitcnt lgkmcnt(5)
    v_mfma_f32_32x32x16_bf16 v[160:175], v[208:211], v[56:59], v[160:175]
    ds_read_b128 v[208:211], v5 offset:24576
    ds_read_b64_tr_b16 v[232:233], v9 offset:0
    ds_read_b64_tr_b16 v[234:235], v9 offset:2048
    s_add_u32 m0, s46, 0
    s_add_u32 s47, s88, 0x0
    buffer_load_dwordx4 v27, s[64:67], s47 offen offset:1024 sc1 lds
    v_exp_f32 v138, v138
    v_exp_f32 v139, v139
    s_waitcnt lgkmcnt(7)
    v_mfma_f32_32x32x16_bf16 v[160:175], v[212:215], v[60:63], v[160:175]
    ds_read_b128 v[212:215], v6 offset:24576
    ds_read_b64_tr_b16 v[236:237], v10 offset:0
    ds_read_b64_tr_b16 v[238:239], v10 offset:2048
    v_add_f32 v18, v18, v136
    v_add_f32 v19, v19, v137
    v_exp_f32 v140, v140
    s_waitcnt lgkmcnt(9)
    v_mfma_f32_32x32x16_bf16 v[176:191], v[216:219], v[32:35], v[192:207]
    ds_read_b128 v[216:219], v7 offset:24576
    ds_read_b64_tr_b16 v[240:241], v11 offset:0
    ds_read_b64_tr_b16 v[242:243], v11 offset:2048
    s_add_u32 m0, s46, 0
    s_add_u32 s47, s88, 0x0
    buffer_load_dwordx4 v27, s[64:67], s47 offen offset:2048 sc1 lds
    v_add_f32 v18, v18, v138
    v_exp_f32 v141, v141
    v_add_f32 v19, v19, v139
    s_waitcnt lgkmcnt(11)
    v_mfma_f32_32x32x16_bf16 v[176:191], v[220:223], v[36:39], v[176:191]
    ds_read_b128 v[220:223], v8 offset:24576
    ds_read_b64_tr_b16 v[244:245], v12 offset:0
    ds_read_b64_tr_b16 v[246:247], v12 offset:2048
    v_cvt_pk_bf16_f32 v136, v136, v137
    v_exp_f32 v142, v142
    v_add_f32 v18, v18, v140
    s_waitcnt lgkmcnt(13)
    v_mfma_f32_32x32x16_bf16 v[176:191], v[224:227], v[40:43], v[176:191]
    ds_read_b64_tr_b16 v[248:249], v9 offset:4096
    ds_read_b64_tr_b16 v[250:251], v9 offset:6144
    s_add_u32 m0, s46, 0
    s_add_u32 s47, s88, 0x0
    buffer_load_dwordx4 v27, s[64:67], s47 offen offset:3072 sc1 lds
    v_exp_f32 v143, v143
    v_add_f32 v19, v19, v141
    v_cvt_pk_bf16_f32 v137, v138, v139
    s_waitcnt lgkmcnt(14)
    v_mfma_f32_32x32x16_bf16 v[176:191], v[228:231], v[44:47], v[176:191]
    ds_read_b64_tr_b16 v[252:253], v10 offset:4096
    ds_read_b64_tr_b16 v[254:255], v10 offset:6144
    v_add_f32 v18, v18, v142
    v_add_f32 v19, v19, v143
    v_cvt_pk_bf16_f32 v138, v140, v141
    v_cvt_pk_bf16_f32 v139, v142, v143
    v_max3_f32 v20, v160, v161, v162
    v_max3_f32 v20, v20, v163, v164
    s_waitcnt lgkmcnt(15)
    v_mfma_f32_32x32x16_bf16 v[176:191], v[208:211], v[48:51], v[176:191]
    v_exp_f32 v144, v144
    v_exp_f32 v145, v145
    v_max3_f32 v20, v20, v165, v166
    v_max3_f32 v20, v20, v167, v168
    s_waitcnt lgkmcnt(12)
    v_mfma_f32_32x32x16_bf16 v[176:191], v[212:215], v[52:55], v[176:191]
    v_exp_f32 v146, v146
    v_exp_f32 v147, v147
    v_max3_f32 v20, v20, v169, v170
    v_max3_f32 v20, v20, v171, v172
    s_waitcnt lgkmcnt(9)
    v_mfma_f32_32x32x16_bf16 v[176:191], v[216:219], v[56:59], v[176:191]
    v_add_f32 v18, v18, v144
    v_add_f32 v19, v19, v145
    v_exp_f32 v148, v148
    v_max3_f32 v20, v20, v173, v174
    v_max_f32 v20, v20, v175
    s_waitcnt lgkmcnt(6)
    v_mfma_f32_32x32x16_bf16 v[176:191], v[220:223], v[60:63], v[176:191]
    v_add_f32 v18, v18, v146
    v_exp_f32 v149, v149
    v_add_f32 v19, v19, v147
    v_mfma_f32_32x32x16_bf16 v[64:79], v[232:235], v[128:131], v[64:79]
    ds_read_b64_tr_b16 v[232:233], v11 offset:4096
    ds_read_b64_tr_b16 v[234:235], v11 offset:6144
    v_cvt_pk_bf16_f32 v144, v144, v145
    v_exp_f32 v150, v150
    v_add_f32 v18, v18, v148
    v_mfma_f32_32x32x16_bf16 v[80:95], v[236:239], v[128:131], v[80:95]
    ds_read_b64_tr_b16 v[236:237], v12 offset:4096
    ds_read_b64_tr_b16 v[238:239], v12 offset:6144
    v_exp_f32 v151, v151
    v_add_f32 v19, v19, v149
    v_cvt_pk_bf16_f32 v145, v146, v147
    v_mfma_f32_32x32x16_bf16 v[96:111], v[240:243], v[128:131], v[96:111]
    ds_read_b64_tr_b16 v[240:241], v9 offset:8192
    ds_read_b64_tr_b16 v[242:243], v9 offset:10240
    v_add_f32 v18, v18, v150
    v_add_f32 v19, v19, v151
    v_cvt_pk_bf16_f32 v146, v148, v149
    v_cvt_pk_bf16_f32 v147, v150, v151
    s_waitcnt lgkmcnt(10)
    v_mfma_f32_32x32x16_bf16 v[112:127], v[244:247], v[128:131], v[112:127]
    ds_read_b64_tr_b16 v[244:245], v10 offset:8192
    ds_read_b64_tr_b16 v[246:247], v10 offset:10240
    v_exp_f32 v152, v152
    v_exp_f32 v153, v153
    s_waitcnt lgkmcnt(10)
    v_mfma_f32_32x32x16_bf16 v[64:79], v[248:251], v[136:139], v[64:79]
    ds_read_b64_tr_b16 v[248:249], v11 offset:8192
    ds_read_b64_tr_b16 v[250:251], v11 offset:10240
    v_exp_f32 v154, v154
    v_exp_f32 v155, v155
    s_waitcnt lgkmcnt(10)
    v_mfma_f32_32x32x16_bf16 v[80:95], v[252:255], v[136:139], v[80:95]
    ds_read_b64_tr_b16 v[252:253], v12 offset:8192
    ds_read_b64_tr_b16 v[254:255], v12 offset:10240
    v_add_f32 v18, v18, v152
    v_add_f32 v19, v19, v153
    v_exp_f32 v156, v156
    s_waitcnt lgkmcnt(10)
    v_mfma_f32_32x32x16_bf16 v[96:111], v[232:235], v[136:139], v[96:111]
    ds_read_b64_tr_b16 v[232:233], v9 offset:12288
    ds_read_b64_tr_b16 v[234:235], v9 offset:14336
    v_add_f32 v18, v18, v154
    v_exp_f32 v157, v157
    v_add_f32 v19, v19, v155
    s_waitcnt lgkmcnt(10)
    v_mfma_f32_32x32x16_bf16 v[112:127], v[236:239], v[136:139], v[112:127]
    ds_read_b64_tr_b16 v[236:237], v10 offset:12288
    ds_read_b64_tr_b16 v[238:239], v10 offset:14336
    v_cvt_pk_bf16_f32 v152, v152, v153
    v_exp_f32 v158, v158
    v_add_f32 v18, v18, v156
    s_waitcnt lgkmcnt(10)
    v_mfma_f32_32x32x16_bf16 v[64:79], v[240:243], v[144:147], v[64:79]
    ds_read_b64_tr_b16 v[240:241], v11 offset:12288
    ds_read_b64_tr_b16 v[242:243], v11 offset:14336
    v_exp_f32 v159, v159
    v_add_f32 v19, v19, v157
    v_cvt_pk_bf16_f32 v153, v154, v155
    s_waitcnt lgkmcnt(10)
    v_mfma_f32_32x32x16_bf16 v[80:95], v[244:247], v[144:147], v[80:95]
    ds_read_b64_tr_b16 v[244:245], v12 offset:12288
    ds_read_b64_tr_b16 v[246:247], v12 offset:14336
    v_add_f32 v18, v18, v158
    v_add_f32 v19, v19, v159
    v_cvt_pk_bf16_f32 v154, v156, v157
    v_cvt_pk_bf16_f32 v155, v158, v159
    s_waitcnt lgkmcnt(10)
    v_mfma_f32_32x32x16_bf16 v[96:111], v[248:251], v[144:147], v[96:111]
    v_max3_f32 v20, v20, v176, v177
    v_max3_f32 v20, v20, v178, v179
    s_waitcnt lgkmcnt(8)
    v_mfma_f32_32x32x16_bf16 v[112:127], v[252:255], v[144:147], v[112:127]
    v_max3_f32 v20, v20, v180, v181
    v_max3_f32 v20, v20, v182, v183
    s_waitcnt lgkmcnt(6)
    v_mfma_f32_32x32x16_bf16 v[64:79], v[232:235], v[152:155], v[64:79]
    v_max3_f32 v20, v20, v184, v185
    v_max3_f32 v20, v20, v186, v187
    s_waitcnt lgkmcnt(4)
    v_mfma_f32_32x32x16_bf16 v[80:95], v[236:239], v[152:155], v[80:95]
    v_max3_f32 v20, v20, v188, v189
    v_max3_f32 v20, v20, v190, v191
    s_waitcnt lgkmcnt(2)
    v_mfma_f32_32x32x16_bf16 v[96:111], v[240:243], v[152:155], v[96:111]
    s_waitcnt lgkmcnt(0)
    v_mfma_f32_32x32x16_bf16 v[112:127], v[244:247], v[152:155], v[112:127]
    v_cmp_lt_f32 vcc, 0x41000000, v20
    s_cbranch_vccnz L_rare_t28
L_ret_t28:
    s_waitcnt vmcnt(24)
    s_barrier
    ds_read_b128 v[208:211], v1 offset:32768
    ds_read_b128 v[212:215], v2 offset:32768
    ds_read_b128 v[216:219], v3 offset:32768
    ds_read_b128 v[220:223], v4 offset:32768
    ds_read_b128 v[224:227], v5 offset:32768
    ds_read_b128 v[228:231], v6 offset:32768
    v_exp_f32 v160, v160
    v_exp_f32 v161, v161
    v_exp_f32 v162, v162
    v_exp_f32 v163, v163
    s_waitcnt lgkmcnt(5)
    v_mfma_f32_32x32x16_bf16 v[128:143], v[208:211], v[32:35], v[192:207]
    ds_read_b128 v[208:211], v7 offset:32768
    s_add_u32 m0, s46, 16384
    s_add_u32 s47, s88, 0x1000
    buffer_load_dwordx4 v27, s[64:67], s47 offen offset:0 sc1 lds
    v_add_f32 v18, v18, v160
    v_add_f32 v19, v19, v161
    v_exp_f32 v164, v164
    s_waitcnt lgkmcnt(5)
    v_mfma_f32_32x32x16_bf16 v[128:143], v[212:215], v[36:39], v[128:143]
    ds_read_b128 v[212:215], v8 offset:32768
    v_add_f32 v18, v18, v162
    v_exp_f32 v165, v165
    v_add_f32 v19, v19, v163
    s_waitcnt lgkmcnt(5)
    v_mfma_f32_32x32x16_bf16 v[128:143], v[216:219], v[40:43], v[128:143]
    ds_read_b128 v[216:219], v1 offset:40960
    s_add_u32 m0, s46, 16384
    s_add_u32 s47, s88, 0x1000
    buffer_load_dwordx4 v27, s[64:67], s47 offen offset:1024 sc1 lds
    v_cvt_pk_bf16_f32 v160, v160, v161
    v_exp_f32 v166, v166
    v_add_f32 v18, v18, v164
    s_waitcnt lgkmcnt(5)
    v_mfma_f32_32x32x16_bf16 v[128:143], v[220:223], v[44:47], v[128:143]
    ds_read_b128 v[220:223], v2 offset:40960
    v_exp_f32 v167, v167
    v_add_f32 v19, v19, v165
    v_cvt_pk_bf16_f32 v161, v162, v163
    s_waitcnt lgkmcnt(5)
    v_mfma_f32_32x32x16_bf16 v[128:143], v[224:227], v[48:51], v[128:143]
    ds_read_b128 v[224:227], v3 offset:40960
    s_add_u32 m0, s46, 16384
    s_add_u32 s47, s88, 0x1000
    buffer_load_dwordx4 v27, s[64:67], s47 offen offset:2048 sc1 lds
    v_add_f32 v18, v18, v166
    v_add_f32 v19, v19, v167
    v_cvt_pk_bf16_f32 v162, v164, v165
    v_cvt_pk_bf16_f32 v163, v166, v167
    s_waitcnt lgkmcnt(5)
    v_mfma_f32_32x32x16_bf16 v[128:143], v[228:231], v[52:55], v[128:143]
    ds_read_b128 v[228:231], v4 offset:40960
    v_exp_f32 v168, v168
    v_exp_f32 v169, v169
    s_waitcnt lgkmcnt(5)
    v_mfma_f32_32x32x16_bf16 v[128:143], v[208:211], v[56:59], v[128:143]
    ds_read_b128 v[208:211], v5 offset:40960
    ds_read_b64_tr_b16 v[232:233], v9 offset:16384
    ds_read_b64_tr_b16 v[234:235], v9 offset:18432
    s_add_u32 m0, s46, 16384
    s_add_u32 s47, s88, 0x1000
    buffer_load_dwordx4 v27, s[64:67], s47 offen offset:3072 sc1 lds
    v_exp_f32 v170, v170
    v_exp_f32 v171, v171
    s_waitcnt lgkmcnt(7)
    v_mfma_f32_32x32x16_bf16 v[128:143], v[212:215], v[60:63], v[128:143]
    ds_read_b128 v[212:215], v6 offset:40960
    ds_read_b64_tr_b16 v[236:237], v10 offset:16384
    ds_read_b64_tr_b16 v[238:239], v10 offset:18432
    v_add_f32 v18, v18, v168
    v_add_f32 v19, v19, v169
    v_exp_f32 v172, v172
    s_waitcnt lgkmcnt(9)
    v_mfma_f32_32x32x16_bf16 v[144:159], v[216:219], v[32:35], v[192:207]
    ds_read_b128 v[216:219], v7 offset:40960
    ds_read_b64_tr_b16 v[240:241], v11 offset:16384
    ds_read_b64_tr_b16 v[242:243], v11 offset:18432
    s_add_u32 m0, s46, 65536
    s_add_u32 s47, s88, 0x2000
    buffer_load_dwordx4 v27, s[64:67], s47 offen offset:0 sc1 lds
    v_add_f32 v18, v18, v170
    v_exp_f32 v173, v173
    v_add_f32 v19, v19, v171
    s_waitcnt lgkmcnt(11)
    v_mfma_f32_32x32x16_bf16 v[144:159], v[220:223], v[36:39], v[144:159]
    ds_read_b128 v[220:223], v8 offset:40960
    ds_read_b64_tr_b16 v[244:245], v12 offset:16384
    ds_read_b64_tr_b16 v[246:247], v12 offset:18432
    v_cvt_pk_bf16_f32 v168, v168, v169
    v_exp_f32 v174, v174
    v_add_f32 v18, v18, v172
    s_waitcnt lgkmcnt(13)
    v_mfma_f32_32x32x16_bf16 v[144:159], v[224:227], v[40:43], v[144:159]
    ds_read_b64_tr_b16 v[248:249], v9 offset:20480
    ds_read_b64_tr_b16 v[250:251], v9 offset:22528
    s_add_u32 m0, s46, 65536
    s_add_u32 s47, s88, 0x2000
    buffer_load_dwordx4 v27, s[64:67], s47 offen offset:1024 sc1 lds
    v_exp_f32 v175, v175
    v_add_f32 v19, v19, v173
    v_cvt_pk_bf16_f32 v169, v170, v171
    s_waitcnt lgkmcnt(14)
    v_mfma_f32_32x32x16_bf16 v[144:159], v[228:231], v[44:47], v[144:159]
    ds_read_b64_tr_b16 v[252:253], v10 offset:20480
    ds_read_b64_tr_b16 v[254:255], v10 offset:22528
    v_add_f32 v18, v18, v174
    v_add_f32 v19, v19, v175
    v_cvt_pk_bf16_f32 v170, v172, v173
    v_cvt_pk_bf16_f32 v171, v174, v175
    v_max3_f32 v20, v128, v129, v130
    v_max3_f32 v20, v20, v131, v132
    s_waitcnt lgkmcnt(15)
    v_mfma_f32_32x32x16_bf16 v[144:159], v[208:211], v[48:51], v[144:159]
    s_add_u32 m0, s46, 65536
    s_add_u32 s47, s88, 0x2000
    buffer_load_dwordx4 v27, s[64:67], s47 offen offset:2048 sc1 lds
    v_exp_f32 v176, v176
    v_exp_f32 v177, v177
    v_max3_f32 v20, v20, v133, v134
    v_max3_f32 v20, v20, v135, v136
    s_waitcnt lgkmcnt(12)
    v_mfma_f32_32x32x16_bf16 v[144:159], v[212:215], v[52:55], v[144:159]
    v_exp_f32 v178, v178
    v_exp_f32 v179, v179
    v_max3_f32 v20, v20, v137, v138
    v_max3_f32 v20, v20, v139, v140
    s_waitcnt lgkmcnt(9)
    v_mfma_f32_32x32x16_bf16 v[144:159], v[216:219], v[56:59], v[144:159]
    s_add_u32 m0, s46, 65536
    s_add_u32 s47, s88, 0x2000
    buffer_load_dwordx4 v27, s[64:67], s47 offen offset:3072 sc1 lds
    v_add_f32 v18, v18, v176
    v_add_f32 v19, v19, v177
    v_exp_f32 v180, v180
    v_max3_f32 v20, v20, v141, v142
    v_max_f32 v20, v20, v143
    s_waitcnt lgkmcnt(6)
    v_mfma_f32_32x32x16_bf16 v[144:159], v[220:223], v[60:63], v[144:159]
    v_add_f32 v18, v18, v178
    v_exp_f32 v181, v181
    v_add_f32 v19, v19, v179
    v_mfma_f32_32x32x16_bf16 v[64:79], v[232:235], v[160:163], v[64:79]
    ds_read_b64_tr_b16 v[232:233], v11 offset:20480
    ds_read_b64_tr_b16 v[234:235], v11 offset:22528
    v_cvt_pk_bf16_f32 v176, v176, v177
    v_exp_f32 v182, v182
    v_add_f32 v18, v18, v180
    v_mfma_f32_32x32x16_bf16 v[80:95], v[236:239], v[160:163], v[80:95]
    ds_read_b64_tr_b16 v[236:237], v12 offset:20480
    ds_read_b64_tr_b16 v[238:239], v12 offset:22528
    v_exp_f32 v183, v183
    v_add_f32 v19, v19, v181
    v_cvt_pk_bf16_f32 v177, v178, v179
    v_mfma_f32_32x32x16_bf16 v[96:111], v[240:243], v[160:163], v[96:111]
    ds_read_b64_tr_b16 v[240:241], v9 offset:24576
    ds_read_b64_tr_b16 v[242:243], v9 offset:26624
    v_add_f32 v18, v18, v182
    v_add_f32 v19, v19, v183
    v_cvt_pk_bf16_f32 v178, v180, v181
    v_cvt_pk_bf16_f32 v179, v182, v183
    s_waitcnt lgkmcnt(10)
    v_mfma_f32_32x32x16_bf16 v[112:127], v[244:247], v[160:163], v[112:127]
    ds_read_b64_tr_b16 v[244:245], v10 offset:24576
    ds_read_b64_tr_b16 v[246:247], v10 offset:26624
    v_exp_f32 v184, v184
    v_exp_f32 v185, v185
    s_waitcnt lgkmcnt(10)
    v_mfma_f32_32x32x16_bf16 v[64:79], v[248:251], v[168:171], v[64:79]
    ds_read_b64_tr_b16 v[248:249], v11 offset:24576
    ds_read_b64_tr_b16 v[250:251], v11 offset:26624
    v_exp_f32 v186, v186
    v_exp_f32 v187, v187
    s_waitcnt lgkmcnt(10)
    v_mfma_f32_32x32x16_bf16 v[80:95], v[252:255], v[168:171], v[80:95]
    ds_read_b64_tr_b16 v[252:253], v12 offset:24576
    ds_read_b64_tr_b16 v[254:255], v12 offset:26624
    v_add_f32 v18, v18, v184
    v_add_f32 v19, v19, v185
    v_exp_f32 v188, v188
    s_waitcnt lgkmcnt(10)
    v_mfma_f32_32x32x16_bf16 v[96:111], v[232:235], v[168:171], v[96:111]
    ds_read_b64_tr_b16 v[232:233], v9 offset:28672
    ds_read_b64_tr_b16 v[234:235], v9 offset:30720
    v_add_f32 v18, v18, v186
    v_exp_f32 v189, v189
    v_add_f32 v19, v19, v187
    s_waitcnt lgkmcnt(10)
    v_mfma_f32_32x32x16_bf16 v[112:127], v[236:239], v[168:171], v[112:127]
    ds_read_b64_tr_b16 v[236:237], v10 offset:28672
    ds_read_b64_tr_b16 v[238:239], v10 offset:30720
    v_cvt_pk_bf16_f32 v184, v184, v185
    v_exp_f32 v190, v190
    v_add_f32 v18, v18, v188
    s_waitcnt lgkmcnt(10)
    v_mfma_f32_32x32x16_bf16 v[64:79], v[240:243], v[176:179], v[64:79]
    ds_read_b64_tr_b16 v[240:241], v11 offset:28672
    ds_read_b64_tr_b16 v[242:243], v11 offset:30720
    v_exp_f32 v191, v191
    v_add_f32 v19, v19, v189
    v_cvt_pk_bf16_f32 v185, v186, v187
    s_waitcnt lgkmcnt(10)
    v_mfma_f32_32x32x16_bf16 v[80:95], v[244:247], v[176:179], v[80:95]
    ds_read_b64_tr_b16 v[244:245], v12 offset:28672
    ds_read_b64_tr_b16 v[246:247], v12 offset:30720
    v_add_f32 v18, v18, v190
    v_add_f32 v19, v19, v191
    v_cvt_pk_bf16_f32 v186, v188, v189
    v_cvt_pk_bf16_f32 v187, v190, v191
    s_waitcnt lgkmcnt(10)
    v_mfma_f32_32x32x16_bf16 v[96:111], v[248:251], v[176:179], v[96:111]
    v_max3_f32 v20, v20, v144, v145
    v_max3_f32 v20, v20, v146, v147
    s_waitcnt lgkmcnt(8)
    v_mfma_f32_32x32x16_bf16 v[112:127], v[252:255], v[176:179], v[112:127]
    v_max3_f32 v20, v20, v148, v149
    v_max3_f32 v20, v20, v150, v151
    s_waitcnt lgkmcnt(6)
    v_mfma_f32_32x32x16_bf16 v[64:79], v[232:235], v[184:187], v[64:79]
    v_max3_f32 v20, v20, v152, v153
    v_max3_f32 v20, v20, v154, v155
    s_waitcnt lgkmcnt(4)
    v_mfma_f32_32x32x16_bf16 v[80:95], v[236:239], v[184:187], v[80:95]
    v_max3_f32 v20, v20, v156, v157
    v_max3_f32 v20, v20, v158, v159
    s_waitcnt lgkmcnt(2)
    v_mfma_f32_32x32x16_bf16 v[96:111], v[240:243], v[184:187], v[96:111]
    s_waitcnt lgkmcnt(0)
    v_mfma_f32_32x32x16_bf16 v[112:127], v[244:247], v[184:187], v[112:127]
    v_cmp_lt_f32 vcc, 0x41000000, v20
    s_cbranch_vccnz L_rare_t29
L_ret_t29:
    s_waitcnt vmcnt(16)
    s_barrier
    ds_read_b128 a[192:195], v24 offset:0
    ds_read_b128 a[196:199], v24 offset:1024
    ds_read_b128 a[200:203], v24 offset:2048
    ds_read_b128 a[204:207], v24 offset:3072
    ds_read_b128 a[208:211], v24 offset:4096
    ds_read_b128 a[212:215], v24 offset:5120
    ds_read_b128 a[216:219], v24 offset:6144
    ds_read_b128 a[220:223], v24 offset:7168
    ds_read_b128 v[208:211], v1 offset:49152
    ds_read_b128 v[212:215], v2 offset:49152
    ds_read_b128 v[216:219], v3 offset:49152
    ds_read_b128 v[220:223], v4 offset:49152
    ds_read_b128 v[224:227], v5 offset:49152
    ds_read_b128 v[228:231], v6 offset:49152
    v_exp_f32 v128, v128
    v_exp_f32 v129, v129
    v_exp_f32 v130, v130
    v_exp_f32 v131, v131
    s_waitcnt lgkmcnt(5)
    v_mfma_f32_32x32x16_bf16 v[160:175], v[208:211], v[32:35], v[192:207]
    ds_read_b128 v[208:211], v7 offset:49152
    s_add_u32 m0, s57, 0
    s_add_u32 s47, s87, 0x2000
    buffer_load_dwordx4 v27, s[64:67], s47 offen offset:0 sc1 lds
    v_add_f32 v18, v18, v128
    v_add_f32 v19, v19, v129
    v_exp_f32 v132, v132
    s_waitcnt lgkmcnt(5)
    v_mfma_f32_32x32x16_bf16 v[160:175], v[212:215], v[36:39], v[160:175]
    ds_read_b128 v[212:215], v8 offset:49152
    v_add_f32 v18, v18, v130
    v_exp_f32 v133, v133
    v_add_f32 v19, v19, v131
    s_waitcnt lgkmcnt(5)
    v_mfma_f32_32x32x16_bf16 v[160:175], v[216:219], v[40:43], v[160:175]
    ds_read_b128 v[216:219], v1 offset:57344
    s_add_u32 m0, s57, 0
    s_add_u32 s47, s87, 0x2000
    buffer_load_dwordx4 v27, s[64:67], s47 offen offset:1024 sc1 lds
    v_cvt_pk_bf16_f32 v128, v128, v129
    v_exp_f32 v134, v134
    v_add_f32 v18, v18, v132
    s_waitcnt lgkmcnt(5)
    v_mfma_f32_32x32x16_bf16 v[160:175], v[220:223], v[44:47], v[160:175]
    ds_read_b128 v[220:223], v2 offset:57344
    v_exp_f32 v135, v135
    v_add_f32 v19, v19, v133
    v_cvt_pk_bf16_f32 v129, v130, v131
    s_waitcnt lgkmcnt(5)
    v_mfma_f32_32x32x16_bf16 v[160:175], v[224:227], v[48:51], v[160:175]
    ds_read_b128 v[224:227], v3 offset:57344
    s_add_u32 m0, s57, 0
    s_add_u32 s47, s87, 0x2000
    buffer_load_dwordx4 v27, s[64:67], s47 offen offset:2048 sc1 lds
    v_add_f32 v18, v18, v134
    v_add_f32 v19, v19, v135
    v_cvt_pk_bf16_f32 v130, v132, v133
    v_cvt_pk_bf16_f32 v131, v134, v135
    s_waitcnt lgkmcnt(5)
    v_mfma_f32_32x32x16_bf16 v[160:175], v[228:231], v[52:55], v[160:175]
    ds_read_b128 v[228:231], v4 offset:57344
    v_exp_f32 v136, v136
    v_exp_f32 v137, v137
    s_waitcnt lgkmcnt(5)
    v_mfma_f32_32x32x16_bf16 v[160:175], v[208:211], v[56:59], v[160:175]
    ds_read_b128 v[208:211], v5 offset:57344
    ds_read_b64_tr_b16 v[232:233], v9 offset:32768
    ds_read_b64_tr_b16 v[234:235], v9 offset:34816
    s_add_u32 m0, s57, 0
    s_add_u32 s47, s87, 0x2000
    buffer_load_dwordx4 v27, s[64:67], s47 offen offset:3072 sc1 lds
    v_exp_f32 v138, v138
    v_exp_f32 v139, v139
    s_waitcnt lgkmcnt(7)
    v_mfma_f32_32x32x16_bf16 v[160:175], v[212:215], v[60:63], v[160:175]
    ds_read_b128 v[212:215], v6 offset:57344
    ds_read_b64_tr_b16 v[236:237], v10 offset:32768
    ds_read_b64_tr_b16 v[238:239], v10 offset:34816
    v_add_f32 v18, v18, v136
    v_add_f32 v19, v19, v137
    v_exp_f32 v140, v140
    s_waitcnt lgkmcnt(9)
    v_mfma_f32_32x32x16_bf16 v[176:191], v[216:219], v[32:35], v[192:207]
    ds_read_b128 v[216:219], v7 offset:57344
    ds_read_b64_tr_b16 v[240:241], v11 offset:32768
    ds_read_b64_tr_b16 v[242:243], v11 offset:34816
    s_add_u32 m0, s57, 4096
    s_add_u32 s47, s87, 0x3000
    buffer_load_dwordx4 v27, s[64:67], s47 offen offset:0 sc1 lds
    v_add_f32 v18, v18, v138
    v_exp_f32 v141, v141
    v_add_f32 v19, v19, v139
    s_waitcnt lgkmcnt(11)
    v_mfma_f32_32x32x16_bf16 v[176:191], v[220:223], v[36:39], v[176:191]
    ds_read_b128 v[220:223], v8 offset:57344
    ds_read_b64_tr_b16 v[244:245], v12 offset:32768
    ds_read_b64_tr_b16 v[246:247], v12 offset:34816
    v_cvt_pk_bf16_f32 v136, v136, v137
    v_exp_f32 v142, v142
    v_add_f32 v18, v18, v140
    s_waitcnt lgkmcnt(13)
    v_mfma_f32_32x32x16_bf16 v[176:191], v[224:227], v[40:43], v[176:191]
    ds_read_b64_tr_b16 v[248:249], v9 offset:36864
    ds_read_b64_tr_b16 v[250:251], v9 offset:38912
    s_add_u32 m0, s57, 4096
    s_add_u32 s47, s87, 0x3000
    buffer_load_dwordx4 v27, s[64:67], s47 offen offset:1024 sc1 lds
    v_exp_f32 v143, v143
    v_add_f32 v19, v19, v141
    v_cvt_pk_bf16_f32 v137, v138, v139
    s_waitcnt lgkmcnt(14)
    v_mfma_f32_32x32x16_bf16 v[176:191], v[228:231], v[44:47], v[176:191]
    ds_read_b64_tr_b16 v[252:253], v10 offset:36864
    ds_read_b64_tr_b16 v[254:255], v10 offset:38912
    v_add_f32 v18, v18, v142
    v_add_f32 v19, v19, v143
    v_cvt_pk_bf16_f32 v138, v140, v141
    v_cvt_pk_bf16_f32 v139, v142, v143
    v_max3_f32 v20, v160, v161, v162
    v_max3_f32 v20, v20, v163, v164
    s_waitcnt lgkmcnt(15)
    v_mfma_f32_32x32x16_bf16 v[176:191], v[208:211], v[48:51], v[176:191]
    s_add_u32 m0, s57, 4096
    s_add_u32 s47, s87, 0x3000
    buffer_load_dwordx4 v27, s[64:67], s47 offen offset:2048 sc1 lds
    v_exp_f32 v144, v144
    v_exp_f32 v145, v145
    v_max3_f32 v20, v20, v165, v166
    v_max3_f32 v20, v20, v167, v168
    s_waitcnt lgkmcnt(12)
    v_mfma_f32_32x32x16_bf16 v[176:191], v[212:215], v[52:55], v[176:191]
    v_exp_f32 v146, v146
    v_exp_f32 v147, v147
    v_max3_f32 v20, v20, v169, v170
    v_max3_f32 v20, v20, v171, v172
    s_waitcnt lgkmcnt(9)
    v_mfma_f32_32x32x16_bf16 v[176:191], v[216:219], v[56:59], v[176:191]
    s_add_u32 m0, s57, 4096
    s_add_u32 s47, s87, 0x3000
    buffer_load_dwordx4 v27, s[64:67], s47 offen offset:3072 sc1 lds
    v_add_f32 v18, v18, v144
    v_add_f32 v19, v19, v145
    v_exp_f32 v148, v148
    v_max3_f32 v20, v20, v173, v174
    v_max_f32 v20, v20, v175
    s_waitcnt lgkmcnt(6)
    v_mfma_f32_32x32x16_bf16 v[176:191], v[220:223], v[60:63], v[176:191]
    v_add_f32 v18, v18, v146
    v_exp_f32 v149, v149
    v_add_f32 v19, v19, v147
    v_mfma_f32_32x32x16_bf16 v[64:79], v[232:235], v[128:131], v[64:79]
    ds_read_b64_tr_b16 v[232:233], v11 offset:36864
    ds_read_b64_tr_b16 v[234:235], v11 offset:38912
    s_add_u32 m0, s46, 32768
    s_add_u32 s47, s88, 0x3000
    buffer_load_dwordx4 v27, s[64:67], s47 offen offset:0 sc1 lds
    v_cvt_pk_bf16_f32 v144, v144, v145
    v_exp_f32 v150, v150
    v_add_f32 v18, v18, v148
    v_mfma_f32_32x32x16_bf16 v[80:95], v[236:239], v[128:131], v[80:95]
    ds_read_b64_tr_b16 v[236:237], v12 offset:36864
    ds_read_b64_tr_b16 v[238:239], v12 offset:38912
    v_exp_f32 v151, v151
    v_add_f32 v19, v19, v149
    v_cvt_pk_bf16_f32 v145, v146, v147
    v_mfma_f32_32x32x16_bf16 v[96:111], v[240:243], v[128:131], v[96:111]
    ds_read_b64_tr_b16 v[240:241], v9 offset:40960
    ds_read_b64_tr_b16 v[242:243], v9 offset:43008
    s_add_u32 m0, s46, 32768
    s_add_u32 s47, s88, 0x3000
    buffer_load_dwordx4 v27, s[64:67], s47 offen offset:1024 sc1 lds
    v_add_f32 v18, v18, v150
    v_add_f32 v19, v19, v151
    v_cvt_pk_bf16_f32 v146, v148, v149
    v_cvt_pk_bf16_f32 v147, v150, v151
    s_waitcnt lgkmcnt(10)
    v_mfma_f32_32x32x16_bf16 v[112:127], v[244:247], v[128:131], v[112:127]
    ds_read_b64_tr_b16 v[244:245], v10 offset:40960
    ds_read_b64_tr_b16 v[246:247], v10 offset:43008
    v_exp_f32 v152, v152
    v_exp_f32 v153, v153
    s_waitcnt lgkmcnt(10)
    v_mfma_f32_32x32x16_bf16 v[64:79], v[248:251], v[136:139], v[64:79]
    ds_read_b64_tr_b16 v[248:249], v11 offset:40960
    ds_read_b64_tr_b16 v[250:251], v11 offset:43008
    s_add_u32 m0, s46, 32768
    s_add_u32 s47, s88, 0x3000
    buffer_load_dwordx4 v27, s[64:67], s47 offen offset:2048 sc1 lds
    v_exp_f32 v154, v154
    v_exp_f32 v155, v155
    s_waitcnt lgkmcnt(10)
    v_mfma_f32_32x32x16_bf16 v[80:95], v[252:255], v[136:139], v[80:95]
    ds_read_b64_tr_b16 v[252:253], v12 offset:40960
    ds_read_b64_tr_b16 v[254:255], v12 offset:43008
    v_add_f32 v18, v18, v152
    v_add_f32 v19, v19, v153
    v_exp_f32 v156, v156
    s_waitcnt lgkmcnt(10)
    v_mfma_f32_32x32x16_bf16 v[96:111], v[232:235], v[136:139], v[96:111]
    ds_read_b64_tr_b16 v[232:233], v9 offset:45056
    ds_read_b64_tr_b16 v[234:235], v9 offset:47104
    s_add_u32 m0, s46, 32768
    s_add_u32 s47, s88, 0x3000
    buffer_load_dwordx4 v27, s[64:67], s47 offen offset:3072 sc1 lds
    v_add_f32 v18, v18, v154
    v_exp_f32 v157, v157
    v_add_f32 v19, v19, v155
    s_waitcnt lgkmcnt(10)
    v_mfma_f32_32x32x16_bf16 v[112:127], v[236:239], v[136:139], v[112:127]
    ds_read_b64_tr_b16 v[236:237], v10 offset:45056
    ds_read_b64_tr_b16 v[238:239], v10 offset:47104
    v_cvt_pk_bf16_f32 v152, v152, v153
    v_exp_f32 v158, v158
    v_add_f32 v18, v18, v156
    s_waitcnt lgkmcnt(10)
    v_mfma_f32_32x32x16_bf16 v[64:79], v[240:243], v[144:147], v[64:79]
    ds_read_b64_tr_b16 v[240:241], v11 offset:45056
    ds_read_b64_tr_b16 v[242:243], v11 offset:47104
    s_add_u32 m0, s46, 81920
    s_add_u32 s47, s89, 0x0
    buffer_load_dwordx4 v27, s[64:67], s47 offen offset:0 sc1 lds
    v_exp_f32 v159, v159
    v_add_f32 v19, v19, v157
    v_cvt_pk_bf16_f32 v153, v154, v155
    s_waitcnt lgkmcnt(10)
    v_mfma_f32_32x32x16_bf16 v[80:95], v[244:247], v[144:147], v[80:95]
    ds_read_b64_tr_b16 v[244:245], v12 offset:45056
    ds_read_b64_tr_b16 v[246:247], v12 offset:47104
    v_add_f32 v18, v18, v158
    v_add_f32 v19, v19, v159
    v_cvt_pk_bf16_f32 v154, v156, v157
    v_cvt_pk_bf16_f32 v155, v158, v159
    s_waitcnt lgkmcnt(10)
    v_mfma_f32_32x32x16_bf16 v[96:111], v[248:251], v[144:147], v[96:111]
    s_add_u32 m0, s46, 81920
    s_add_u32 s47, s89, 0x0
    buffer_load_dwordx4 v27, s[64:67], s47 offen offset:1024 sc1 lds
    v_max3_f32 v20, v20, v176, v177
    v_max3_f32 v20, v20, v178, v179
    s_waitcnt lgkmcnt(8)
    v_mfma_f32_32x32x16_bf16 v[112:127], v[252:255], v[144:147], v[112:127]
    v_max3_f32 v20, v20, v180, v181
    v_max3_f32 v20, v20, v182, v183
    s_waitcnt lgkmcnt(6)
    v_mfma_f32_32x32x16_bf16 v[64:79], v[232:235], v[152:155], v[64:79]
    s_add_u32 m0, s46, 81920
    s_add_u32 s47, s89, 0x0
    buffer_load_dwordx4 v27, s[64:67], s47 offen offset:2048 sc1 lds
    v_max3_f32 v20, v20, v184, v185
    v_max3_f32 v20, v20, v186, v187
    s_waitcnt lgkmcnt(4)
    v_mfma_f32_32x32x16_bf16 v[80:95], v[236:239], v[152:155], v[80:95]
    v_max3_f32 v20, v20, v188, v189
    v_max3_f32 v20, v20, v190, v191
    s_waitcnt lgkmcnt(2)
    v_mfma_f32_32x32x16_bf16 v[96:111], v[240:243], v[152:155], v[96:111]
    s_add_u32 m0, s46, 81920
    s_add_u32 s47, s89, 0x0
    buffer_load_dwordx4 v27, s[64:67], s47 offen offset:3072 sc1 lds
    s_waitcnt lgkmcnt(0)
    v_mfma_f32_32x32x16_bf16 v[112:127], v[244:247], v[152:155], v[112:127]
    v_cmp_lt_f32 vcc, 0x41000000, v20
    s_cbranch_vccnz L_rare_t30
L_ret_t30:
    v_exp_f32 v160, v160
    v_exp_f32 v161, v161
    v_exp_f32 v162, v162
    v_exp_f32 v163, v163
    v_add_f32 v18, v18, v160
    v_add_f32 v19, v19, v161
    v_exp_f32 v164, v164
    v_add_f32 v18, v18, v162
    v_exp_f32 v165, v165
    v_add_f32 v19, v19, v163
    v_cvt_pk_bf16_f32 v160, v160, v161
    v_exp_f32 v166, v166
    v_add_f32 v18, v18, v164
    v_exp_f32 v167, v167
    v_add_f32 v19, v19, v165
    v_cvt_pk_bf16_f32 v161, v162, v163
    v_add_f32 v18, v18, v166
    v_add_f32 v19, v19, v167
    v_cvt_pk_bf16_f32 v162, v164, v165
    v_cvt_pk_bf16_f32 v163, v166, v167
    v_exp_f32 v168, v168
    v_exp_f32 v169, v169
    v_exp_f32 v170, v170
    v_exp_f32 v171, v171
    v_add_f32 v18, v18, v168
    v_add_f32 v19, v19, v169
    v_exp_f32 v172, v172
    v_add_f32 v18, v18, v170
    v_exp_f32 v173, v173
    v_add_f32 v19, v19, v171
    v_cvt_pk_bf16_f32 v168, v168, v169
    v_exp_f32 v174, v174
    v_add_f32 v18, v18, v172
    v_exp_f32 v175, v175
    v_add_f32 v19, v19, v173
    v_cvt_pk_bf16_f32 v169, v170, v171
    v_add_f32 v18, v18, v174
    v_add_f32 v19, v19, v175
    v_cvt_pk_bf16_f32 v170, v172, v173
    v_cvt_pk_bf16_f32 v171, v174, v175
    v_exp_f32 v176, v176
    v_exp_f32 v177, v177
    v_exp_f32 v178, v178
    v_exp_f32 v179, v179
    v_add_f32 v18, v18, v176
    v_add_f32 v19, v19, v177
    v_exp_f32 v180, v180
    v_add_f32 v18, v18, v178
    v_exp_f32 v181, v181
    v_add_f32 v19, v19, v179
    v_cvt_pk_bf16_f32 v176, v176, v177
    v_exp_f32 v182, v182
    v_add_f32 v18, v18, v180
    v_exp_f32 v183, v183
    v_add_f32 v19, v19, v181
    v_cvt_pk_bf16_f32 v177, v178, v179
    v_add_f32 v18, v18, v182
    v_add_f32 v19, v19, v183
    v_cvt_pk_bf16_f32 v178, v180, v181
    v_cvt_pk_bf16_f32 v179, v182, v183
    v_exp_f32 v184, v184
    v_exp_f32 v185, v185
    v_exp_f32 v186, v186
    v_exp_f32 v187, v187
    v_add_f32 v18, v18, v184
    v_add_f32 v19, v19, v185
    v_exp_f32 v188, v188
    v_add_f32 v18, v18, v186
    v_exp_f32 v189, v189
    v_add_f32 v19, v19, v187
    v_cvt_pk_bf16_f32 v184, v184, v185
    v_exp_f32 v190, v190
    v_add_f32 v18, v18, v188
    v_exp_f32 v191, v191
    v_add_f32 v19, v19, v189
    v_cvt_pk_bf16_f32 v185, v186, v187
    v_add_f32 v18, v18, v190
    v_add_f32 v19, v19, v191
    v_cvt_pk_bf16_f32 v186, v188, v189
    v_cvt_pk_bf16_f32 v187, v190, v191
    v_add_f32 v18, v18, v19
    v_mov_b32 v21, v18
    s_nop 1
    v_permlane32_swap_b32 v18, v21
    v_add_f32 v18, v18, v21
    v_rcp_f32 v18, v18
    v_add_u32 v22, 4096, v27
    s_waitcnt vmcnt(28)
    s_barrier
    buffer_load_dword v30, v29, s[76:79], 0 offen offset:0 sc1
    ds_read_b64_tr_b16 v[232:233], v9 offset:49152
    ds_read_b64_tr_b16 v[234:235], v9 offset:51200
    ds_read_b64_tr_b16 v[236:237], v9 offset:53248
    ds_read_b64_tr_b16 v[238:239], v9 offset:55296
    ds_read_b64_tr_b16 v[240:241], v9 offset:57344
    ds_read_b64_tr_b16 v[242:243], v9 offset:59392
    ds_read_b64_tr_b16 v[244:245], v9 offset:61440
    ds_read_b64_tr_b16 v[246:247], v9 offset:63488
    ds_read_b64_tr_b16 v[248:249], v10 offset:49152
    ds_read_b64_tr_b16 v[250:251], v10 offset:51200
    ds_read_b64_tr_b16 v[252:253], v10 offset:53248
    ds_read_b64_tr_b16 v[254:255], v10 offset:55296
    s_waitcnt lgkmcnt(10)
    v_mfma_f32_32x32x16_bf16 v[64:79], v[232:235], v[160:163], v[64:79]
    ds_read_b64_tr_b16 v[232:233], v10 offset:57344
    ds_read_b64_tr_b16 v[234:235], v10 offset:59392
    s_add_u32 m0, s46, 49152
    s_add_u32 s47, s89, 0x1000
    buffer_load_dwordx4 v27, s[64:67], s47 offen offset:0 sc1 lds
    s_waitcnt lgkmcnt(10)
    v_mfma_f32_32x32x16_bf16 v[64:79], v[236:239], v[168:171], v[64:79]
    ds_read_b64_tr_b16 v[236:237], v10 offset:61440
    ds_read_b64_tr_b16 v[238:239], v10 offset:63488
    s_add_u32 m0, s46, 49152
    s_add_u32 s47, s89, 0x1000
    buffer_load_dwordx4 v27, s[64:67], s47 offen offset:1024 sc1 lds
    s_waitcnt lgkmcnt(10)
    v_mfma_f32_32x32x16_bf16 v[64:79], v[240:243], v[176:179], v[64:79]
    ds_read_b64_tr_b16 v[240:241], v11 offset:49152
    ds_read_b64_tr_b16 v[242:243], v11 offset:51200
    s_add_u32 m0, s46, 49152
    s_add_u32 s47, s89, 0x1000
    buffer_load_dwordx4 v27, s[64:67], s47 offen offset:2048 sc1 lds
    s_waitcnt lgkmcnt(10)
    v_mfma_f32_32x32x16_bf16 v[64:79], v[244:247], v[184:187], v[64:79]
    ds_read_b64_tr_b16 v[244:245], v11 offset:53248
    ds_read_b64_tr_b16 v[246:247], v11 offset:55296
    s_add_u32 m0, s46, 49152
    s_add_u32 s47, s89, 0x1000
    buffer_load_dwordx4 v27, s[64:67], s47 offen offset:3072 sc1 lds
    s_waitcnt lgkmcnt(10)
    v_mfma_f32_32x32x16_bf16 v[80:95], v[248:251], v[160:163], v[80:95]
    ds_read_b64_tr_b16 v[248:249], v11 offset:57344
    ds_read_b64_tr_b16 v[250:251], v11 offset:59392
    s_add_u32 m0, s46, 98304
    s_add_u32 s47, s89, 0x2000
    buffer_load_dwordx4 v27, s[64:67], s47 offen offset:0 sc1 lds
    s_waitcnt lgkmcnt(10)
    v_mfma_f32_32x32x16_bf16 v[80:95], v[252:255], v[168:171], v[80:95]
    ds_read_b64_tr_b16 v[252:253], v11 offset:61440
    ds_read_b64_tr_b16 v[254:255], v11 offset:63488
    s_add_u32 m0, s46, 98304
    s_add_u32 s47, s89, 0x2000
    buffer_load_dwordx4 v27, s[64:67], s47 offen offset:1024 sc1 lds
    s_waitcnt lgkmcnt(10)
    v_mfma_f32_32x32x16_bf16 v[80:95], v[232:235], v[176:179], v[80:95]
    ds_read_b64_tr_b16 v[232:233], v12 offset:49152
    ds_read_b64_tr_b16 v[234:235], v12 offset:51200
    s_add_u32 m0, s46, 98304
    s_add_u32 s47, s89, 0x2000
    buffer_load_dwordx4 v27, s[64:67], s47 offen offset:2048 sc1 lds
    s_waitcnt lgkmcnt(10)
    v_mfma_f32_32x32x16_bf16 v[80:95], v[236:239], v[184:187], v[80:95]
    ds_read_b64_tr_b16 v[236:237], v12 offset:53248
    ds_read_b64_tr_b16 v[238:239], v12 offset:55296
    s_add_u32 m0, s46, 98304
    s_add_u32 s47, s89, 0x2000
    buffer_load_dwordx4 v27, s[64:67], s47 offen offset:3072 sc1 lds
    v_mul_f32 v64, v64, v18
    v_mul_f32 v65, v65, v18
    v_mul_f32 v66, v66, v18
    v_mul_f32 v67, v67, v18
    v_mul_f32 v68, v68, v18
    v_mul_f32 v69, v69, v18
    v_mul_f32 v70, v70, v18
    v_mul_f32 v71, v71, v18
    v_cvt_pk_bf16_f32 v32, v64, v65
    v_cvt_pk_bf16_f32 v33, v66, v67
    v_cvt_pk_bf16_f32 v34, v68, v69
    v_cvt_pk_bf16_f32 v35, v70, v71
    buffer_store_dwordx4 v[32:35], v27, s[36:39], 0 offen offset:0 sc1
    s_waitcnt lgkmcnt(10)
    v_mfma_f32_32x32x16_bf16 v[96:111], v[240:243], v[160:163], v[96:111]
    ds_read_b64_tr_b16 v[240:241], v12 offset:57344
    ds_read_b64_tr_b16 v[242:243], v12 offset:59392
    s_waitcnt lgkmcnt(10)
    v_mfma_f32_32x32x16_bf16 v[96:111], v[244:247], v[168:171], v[96:111]
    ds_read_b64_tr_b16 v[244:245], v12 offset:61440
    ds_read_b64_tr_b16 v[246:247], v12 offset:63488
    v_mul_f32 v72, v72, v18
    v_mul_f32 v73, v73, v18
    v_mul_f32 v74, v74, v18
    v_mul_f32 v75, v75, v18
    v_mul_f32 v76, v76, v18
    v_mul_f32 v77, v77, v18
    v_mul_f32 v78, v78, v18
    v_mul_f32 v79, v79, v18
    v_cvt_pk_bf16_f32 v36, v72, v73
    v_cvt_pk_bf16_f32 v37, v74, v75
    v_cvt_pk_bf16_f32 v38, v76, v77
    v_cvt_pk_bf16_f32 v39, v78, v79
    buffer_store_dwordx4 v[36:39], v27, s[36:39], 0 offen offset:1024 sc1
    s_waitcnt lgkmcnt(10)
    v_mfma_f32_32x32x16_bf16 v[96:111], v[248:251], v[176:179], v[96:111]
    s_waitcnt lgkmcnt(8)
    v_mfma_f32_32x32x16_bf16 v[96:111], v[252:255], v[184:187], v[96:111]
    v_mul_f32 v80, v80, v18
    v_mul_f32 v81, v81, v18
    v_mul_f32 v82, v82, v18
    v_mul_f32 v83, v83, v18
    v_mul_f32 v84, v84, v18
    v_mul_f32 v85, v85, v18
    v_mul_f32 v86, v86, v18
    v_mul_f32 v87, v87, v18
    v_cvt_pk_bf16_f32 v40, v80, v81
    v_cvt_pk_bf16_f32 v41, v82, v83
    v_cvt_pk_bf16_f32 v42, v84, v85
    v_cvt_pk_bf16_f32 v43, v86, v87
    buffer_store_dwordx4 v[40:43], v27, s[36:39], 0 offen offset:2048 sc1
    s_waitcnt lgkmcnt(6)
    v_mfma_f32_32x32x16_bf16 v[112:127], v[232:235], v[160:163], v[112:127]
    s_waitcnt lgkmcnt(4)
    v_mfma_f32_32x32x16_bf16 v[112:127], v[236:239], v[168:171], v[112:127]
    v_mul_f32 v88, v88, v18
    v_mul_f32 v89, v89, v18
    v_mul_f32 v90, v90, v18
    v_mul_f32 v91, v91, v18
    v_mul_f32 v92, v92, v18
    v_mul_f32 v93, v93, v18
    v_mul_f32 v94, v94, v18
    v_mul_f32 v95, v95, v18
    v_cvt_pk_bf16_f32 v44, v88, v89
    v_cvt_pk_bf16_f32 v45, v90, v91
    v_cvt_pk_bf16_f32 v46, v92, v93
    v_cvt_pk_bf16_f32 v47, v94, v95
    buffer_store_dwordx4 v[44:47], v27, s[36:39], 0 offen offset:3072 sc1
    s_waitcnt lgkmcnt(2)
    v_mfma_f32_32x32x16_bf16 v[112:127], v[240:243], v[176:179], v[112:127]
    s_waitcnt lgkmcnt(0)
    v_mfma_f32_32x32x16_bf16 v[112:127], v[244:247], v[184:187], v[112:127]
    v_mul_f32 v96, v96, v18
    v_mul_f32 v97, v97, v18
    v_mul_f32 v98, v98, v18
    v_mul_f32 v99, v99, v18
    v_mul_f32 v100, v100, v18
    v_mul_f32 v101, v101, v18
    v_mul_f32 v102, v102, v18
    v_mul_f32 v103, v103, v18
    v_cvt_pk_bf16_f32 v48, v96, v97
    v_cvt_pk_bf16_f32 v49, v98, v99
    v_cvt_pk_bf16_f32 v50, v100, v101
    v_cvt_pk_bf16_f32 v51, v102, v103
    buffer_store_dwordx4 v[48:51], v22, s[36:39], 0 offen offset:0 sc1
    v_mul_f32 v104, v104, v18
    v_mul_f32 v105, v105, v18
    v_mul_f32 v106, v106, v18
    v_mul_f32 v107, v107, v18
    v_mul_f32 v108, v108, v18
    v_mul_f32 v109, v109, v18
    v_mul_f32 v110, v110, v18
    v_mul_f32 v111, v111, v18
    v_cvt_pk_bf16_f32 v52, v104, v105
    v_cvt_pk_bf16_f32 v53, v106, v107
    v_cvt_pk_bf16_f32 v54, v108, v109
    v_cvt_pk_bf16_f32 v55, v110, v111
    buffer_store_dwordx4 v[52:55], v22, s[36:39], 0 offen offset:1024 sc1
    v_mul_f32 v112, v112, v18
    v_mul_f32 v113, v113, v18
    v_mul_f32 v114, v114, v18
    v_mul_f32 v115, v115, v18
    v_mul_f32 v116, v116, v18
    v_mul_f32 v117, v117, v18
    v_mul_f32 v118, v118, v18
    v_mul_f32 v119, v119, v18
    v_cvt_pk_bf16_f32 v56, v112, v113
    v_cvt_pk_bf16_f32 v57, v114, v115
    v_cvt_pk_bf16_f32 v58, v116, v117
    v_cvt_pk_bf16_f32 v59, v118, v119
    buffer_store_dwordx4 v[56:59], v22, s[36:39], 0 offen offset:2048 sc1
    v_mul_f32 v120, v120, v18
    v_mul_f32 v121, v121, v18
    v_mul_f32 v122, v122, v18
    v_mul_f32 v123, v123, v18
    v_mul_f32 v124, v124, v18
    v_mul_f32 v125, v125, v18
    v_mul_f32 v126, v126, v18
    v_mul_f32 v127, v127, v18
    v_cvt_pk_bf16_f32 v60, v120, v121
    v_cvt_pk_bf16_f32 v61, v122, v123
    v_cvt_pk_bf16_f32 v62, v124, v125
    v_cvt_pk_bf16_f32 v63, v126, v127
    buffer_store_dwordx4 v[60:63], v22, s[36:39], 0 offen offset:3072 sc1
    v_add_u32 v1, s46, v27
    v_add_u32 v2, 65536, v1
    s_waitcnt vmcnt(8)
    v_cmp_ne_u32 vcc, 0, v30
    s_nop 1
    s_mov_b32 s55, vcc_lo
    s_and_b32 s47, s55, 3
    s_cmp_eq_u32 s47, 3
    s_cbranch_scc0 L_slow
    s_lshr_b32 s51, s84, 1
    s_add_u32 s50, s51, 0x1000
    buffer_load_dwordx4 v[64:67], v27, s[68:71], s51 offen offset:0 sc1
    buffer_load_dwordx4 v[68:71], v27, s[68:71], s51 offen offset:1024 sc1
    buffer_load_dwordx4 v[72:75], v27, s[68:71], s51 offen offset:2048 sc1
    buffer_load_dwordx4 v[76:79], v27, s[68:71], s51 offen offset:3072 sc1
    buffer_load_dwordx4 v[80:83], v27, s[68:71], s50 offen offset:0 sc1
    buffer_load_dwordx4 v[84:87], v27, s[68:71], s50 offen offset:1024 sc1
    buffer_load_dwordx4 v[88:91], v27, s[68:71], s50 offen offset:2048 sc1
    buffer_load_dwordx4 v[92:95], v27, s[68:71], s50 offen offset:3072 sc1
    s_lshr_b32 s51, s85, 1
    s_add_u32 s50, s51, 0x1000
    buffer_load_dwordx4 v[96:99], v27, s[68:71], s51 offen offset:0 sc1
    buffer_load_dwordx4 v[100:103], v27, s[68:71], s51 offen offset:1024 sc1
    buffer_load_dwordx4 v[104:107], v27, s[68:71], s51 offen offset:2048 sc1
    buffer_load_dwordx4 v[108:111], v27, s[68:71], s51 offen offset:3072 sc1
    buffer_load_dwordx4 v[112:115], v27, s[68:71], s50 offen offset:0 sc1
    buffer_load_dwordx4 v[116:119], v27, s[68:71], s50 offen offset:1024 sc1
    buffer_load_dwordx4 v[120:123], v27, s[68:71], s50 offen offset:2048 sc1
    buffer_load_dwordx4 v[124:127], v27, s[68:71], s50 offen offset:3072 sc1
    ds_read_b128 a[224:227], v24 offset:0
    ds_read_b128 a[228:231], v24 offset:1024
    ds_read_b128 a[232:235], v24 offset:2048
    ds_read_b128 a[236:239], v24 offset:3072
    ds_read_b128 a[240:243], v24 offset:4096
    ds_read_b128 a[244:247], v24 offset:5120
    ds_read_b128 a[248:251], v24 offset:6144
    ds_read_b128 a[252:255], v24 offset:7168
    ds_read_b128 v[128:131], v1 offset:0
    ds_read_b128 v[132:135], v1 offset:1024
    ds_read_b128 v[136:139], v1 offset:2048
    ds_read_b128 v[140:143], v1 offset:3072
    ds_read_b128 v[144:147], v1 offset:16384
    ds_read_b128 v[148:151], v1 offset:17408
    ds_read_b128 v[152:155], v1 offset:18432
    ds_read_b128 v[156:159], v1 offset:19456
    ds_read_b128 v[160:163], v2 offset:0
    ds_read_b128 v[164:167], v2 offset:1024
    ds_read_b128 v[168:171], v2 offset:2048
    ds_read_b128 v[172:175], v2 offset:3072
    ds_read_b128 v[176:179], v1 offset:32768
    ds_read_b128 v[180:183], v1 offset:33792
    ds_read_b128 v[184:187], v1 offset:34816
    ds_read_b128 v[188:191], v1 offset:35840
    ds_read_b128 v[192:195], v2 offset:16384
    ds_read_b128 v[196:199], v2 offset:17408
    ds_read_b128 v[200:203], v2 offset:18432
    ds_read_b128 v[204:207], v2 offset:19456
    ds_read_b128 v[208:211], v1 offset:49152
    ds_read_b128 v[212:215], v1 offset:50176
    ds_read_b128 v[216:219], v1 offset:51200
    ds_read_b128 v[220:223], v1 offset:52224
    ds_read_b128 v[224:227], v2 offset:32768
    ds_read_b128 v[228:231], v2 offset:33792
    ds_read_b128 v[232:235], v2 offset:34816
    ds_read_b128 v[236:239], v2 offset:35840
    s_waitcnt vmcnt(16)
    v_mov_b32 v20, 1
    s_mov_b64 exec, 1
    buffer_store_dword v20, v28, s[76:79], 0 offen offset:0 sc1
    s_mov_b64 exec, -1
    s_waitcnt lgkmcnt(0)
    s_mov_b32 s96, 0
    s_branch L_join
L_slow:
    ds_read_b128 a[224:227], v24 offset:0
    ds_read_b128 a[228:231], v24 offset:1024
    ds_read_b128 a[232:235], v24 offset:2048
    ds_read_b128 a[236:239], v24 offset:3072
    ds_read_b128 a[240:243], v24 offset:4096
    ds_read_b128 a[244:247], v24 offset:5120
    ds_read_b128 a[248:251], v24 offset:6144
    ds_read_b128 a[252:255], v24 offset:7168
    ds_read_b128 v[128:131], v1 offset:0
    ds_read_b128 v[132:135], v1 offset:1024
    ds_read_b128 v[136:139], v1 offset:2048
    ds_read_b128 v[140:143], v1 offset:3072
    ds_read_b128 v[144:147], v1 offset:16384
    ds_read_b128 v[148:151], v1 offset:17408
    ds_read_b128 v[152:155], v1 offset:18432
    ds_read_b128 v[156:159], v1 offset:19456
    ds_read_b128 v[160:163], v2 offset:0
    ds_read_b128 v[164:167], v2 offset:1024
    ds_read_b128 v[168:171], v2 offset:2048
    ds_read_b128 v[172:175], v2 offset:3072
    ds_read_b128 v[176:179], v1 offset:32768
    ds_read_b128 v[180:183], v1 offset:33792
    ds_read_b128 v[184:187], v1 offset:34816
    ds_read_b128 v[188:191], v1 offset:35840
    ds_read_b128 v[192:195], v2 offset:16384
    ds_read_b128 v[196:199], v2 offset:17408
    ds_read_b128 v[200:203], v2 offset:18432
    ds_read_b128 v[204:207], v2 offset:19456
    ds_read_b128 v[208:211], v1 offset:49152
    ds_read_b128 v[212:215], v1 offset:50176
    ds_read_b128 v[216:219], v1 offset:51200
    ds_read_b128 v[220:223], v1 offset:52224
    ds_read_b128 v[224:227], v2 offset:32768
    ds_read_b128 v[228:231], v2 offset:33792
    ds_read_b128 v[232:235], v2 offset:34816
    ds_read_b128 v[236:239], v2 offset:35840
    s_waitcnt vmcnt(0)
    v_mov_b32 v20, 1
    s_mov_b64 exec, 1
    buffer_store_dword v20, v28, s[76:79], 0 offen offset:0 sc1
    s_mov_b64 exec, -1
    s_waitcnt lgkmcnt(0)
    s_add_u32 m0, s57, 0
    s_add_u32 s47, s89, 0x3000
    buffer_load_dwordx4 v27, s[64:67], s47 offen offset:0 sc1 lds
    s_add_u32 m0, s57, 0
    s_add_u32 s47, s89, 0x3000
    buffer_load_dwordx4 v27, s[64:67], s47 offen offset:1024 sc1 lds
    s_add_u32 m0, s57, 0
    s_add_u32 s47, s89, 0x3000
    buffer_load_dwordx4 v27, s[64:67], s47 offen offset:2048 sc1 lds
    s_add_u32 m0, s57, 0
    s_add_u32 s47, s89, 0x3000
    buffer_load_dwordx4 v27, s[64:67], s47 offen offset:3072 sc1 lds
    s_add_u32 m0, s46, 0
    s_add_u32 s47, s90, 0x0
    buffer_load_dwordx4 v27, s[64:67], s47 offen offset:0 sc1 lds
    s_add_u32 m0, s46, 0
    s_add_u32 s47, s90, 0x0
    buffer_load_dwordx4 v27, s[64:67], s47 offen offset:1024 sc1 lds
    s_add_u32 m0, s46, 0
    s_add_u32 s47, s90, 0x0
    buffer_load_dwordx4 v27, s[64:67], s47 offen offset:2048 sc1 lds
    s_add_u32 m0, s46, 0
    s_add_u32 s47, s90, 0x0
    buffer_load_dwordx4 v27, s[64:67], s47 offen offset:3072 sc1 lds
    s_add_u32 m0, s46, 16384
    s_add_u32 s47, s90, 0x1000
    buffer_load_dwordx4 v27, s[64:67], s47 offen offset:0 sc1 lds
    s_add_u32 m0, s46, 16384
    s_add_u32 s47, s90, 0x1000
    buffer_load_dwordx4 v27, s[64:67], s47 offen offset:1024 sc1 lds
    s_add_u32 m0, s46, 16384
    s_add_u32 s47, s90, 0x1000
    buffer_load_dwordx4 v27, s[64:67], s47 offen offset:2048 sc1 lds
    s_add_u32 m0, s46, 16384
    s_add_u32 s47, s90, 0x1000
    buffer_load_dwordx4 v27, s[64:67], s47 offen offset:3072 sc1 lds
    s_add_u32 m0, s46, 65536
    s_add_u32 s47, s90, 0x2000
    buffer_load_dwordx4 v27, s[64:67], s47 offen offset:0 sc1 lds
    s_add_u32 m0, s46, 65536
    s_add_u32 s47, s90, 0x2000
    buffer_load_dwordx4 v27, s[64:67], s47 offen offset:1024 sc1 lds
    s_add_u32 m0, s46, 65536
    s_add_u32 s47, s90, 0x2000
    buffer_load_dwordx4 v27, s[64:67], s47 offen offset:2048 sc1 lds
    s_add_u32 m0, s46, 65536
    s_add_u32 s47, s90, 0x2000
    buffer_load_dwordx4 v27, s[64:67], s47 offen offset:3072 sc1 lds
    s_add_u32 m0, s46, 32768
    s_add_u32 s47, s90, 0x3000
    buffer_load_dwordx4 v27, s[64:67], s47 offen offset:0 sc1 lds
    s_add_u32 m0, s46, 32768
    s_add_u32 s47, s90, 0x3000
    buffer_load_dwordx4 v27, s[64:67], s47 offen offset:1024 sc1 lds
    s_add_u32 m0, s46, 32768
    s_add_u32 s47, s90, 0x3000
    buffer_load_dwordx4 v27, s[64:67], s47 offen offset:2048 sc1 lds
    s_add_u32 m0, s46, 32768
    s_add_u32 s47, s90, 0x3000
    buffer_load_dwordx4 v27, s[64:67], s47 offen offset:3072 sc1 lds
    s_add_u32 m0, s46, 81920
    s_add_u32 s47, s91, 0x0
    buffer_load_dwordx4 v27, s[64:67], s47 offen offset:0 sc1 lds
    s_add_u32 m0, s46, 81920
    s_add_u32 s47, s91, 0x0
    buffer_load_dwordx4 v27, s[64:67], s47 offen offset:1024 sc1 lds
    s_add_u32 m0, s46, 81920
    s_add_u32 s47, s91, 0x0
    buffer_load_dwordx4 v27, s[64:67], s47 offen offset:2048 sc1 lds
    s_add_u32 m0, s46, 81920
    s_add_u32 s47, s91, 0x0
    buffer_load_dwordx4 v27, s[64:67], s47 offen offset:3072 sc1 lds
    s_add_u32 m0, s46, 49152
    s_add_u32 s47, s91, 0x1000
    buffer_load_dwordx4 v27, s[64:67], s47 offen offset:0 sc1 lds
    s_add_u32 m0, s46, 49152
    s_add_u32 s47, s91, 0x1000
    buffer_load_dwordx4 v27, s[64:67], s47 offen offset:1024 sc1 lds
    s_add_u32 m0, s46, 49152
    s_add_u32 s47, s91, 0x1000
    buffer_load_dwordx4 v27, s[64:67], s47 offen offset:2048 sc1 lds
    s_add_u32 m0, s46, 49152
    s_add_u32 s47, s91, 0x1000
    buffer_load_dwordx4 v27, s[64:67], s47 offen offset:3072 sc1 lds
    s_add_u32 m0, s46, 98304
    s_add_u32 s47, s91, 0x2000
    buffer_load_dwordx4 v27, s[64:67], s47 offen offset:0 sc1 lds
    s_add_u32 m0, s46, 98304
    s_add_u32 s47, s91, 0x2000
    buffer_load_dwordx4 v27, s[64:67], s47 offen offset:1024 sc1 lds
    s_add_u32 m0, s46, 98304
    s_add_u32 s47, s91, 0x2000
    buffer_load_dwordx4 v27, s[64:67], s47 offen offset:2048 sc1 lds
    s_add_u32 m0, s46, 98304
    s_add_u32 s47, s91, 0x2000
    buffer_load_dwordx4 v27, s[64:67], s47 offen offset:3072 sc1 lds
    s_add_u32 m0, s57, 4096
    s_add_u32 s47, s91, 0x3000
    buffer_load_dwordx4 v27, s[64:67], s47 offen offset:0 sc1 lds
    s_add_u32 m0, s57, 4096
    s_add_u32 s47, s91, 0x3000
    buffer_load_dwordx4 v27, s[64:67], s47 offen offset:1024 sc1 lds
    s_add_u32 m0, s57, 4096
    s_add_u32 s47, s91, 0x3000
    buffer_load_dwordx4 v27, s[64:67], s47 offen offset:2048 sc1 lds
    s_add_u32 m0, s57, 4096
    s_add_u32 s47, s91, 0x3000
    buffer_load_dwordx4 v27, s[64:67], s47 offen offset:3072 sc1 lds
    s_mov_b32 s96, 1
    s_bitcmp1_b32 s55, 0
    s_cbranch_scc1 L_ok_0
L_spin_0:
    buffer_load_dword v30, v29, s[76:79], 0 offen sc1
    s_waitcnt vmcnt(0)
    v_cmp_ne_u32 vcc, 0, v30
    s_nop 1
    s_mov_b32 s55, vcc_lo
    s_bitcmp1_b32 s55, 0
    s_cbranch_scc1 L_ok_0
    s_sleep 1
    s_sub_u32 s56, s56, 1
    s_cmp_lg_u32 s56, 0
    s_cbranch_scc1 L_spin_0
    s_branch L_done
L_ok_0:
    s_lshr_b32 s51, s84, 1
    s_add_u32 s50, s51, 0x1000
    buffer_load_dwordx4 v[64:67], v27, s[68:71], s51 offen offset:0 sc1
    buffer_load_dwordx4 v[68:71], v27, s[68:71], s51 offen offset:1024 sc1
    buffer_load_dwordx4 v[72:75], v27, s[68:71], s51 offen offset:2048 sc1
    buffer_load_dwordx4 v[76:79], v27, s[68:71], s51 offen offset:3072 sc1
    buffer_load_dwordx4 v[80:83], v27, s[68:71], s50 offen offset:0 sc1
    buffer_load_dwordx4 v[84:87], v27, s[68:71], s50 offen offset:1024 sc1
    buffer_load_dwordx4 v[88:91], v27, s[68:71], s50 offen offset:2048 sc1
    buffer_load_dwordx4 v[92:95], v27, s[68:71], s50 offen offset:3072 sc1
    s_bitcmp1_b32 s55, 1
    s_cbranch_scc1 L_ok_1
L_spin_1:
    buffer_load_dword v30, v29, s[76:79], 0 offen sc1
    s_waitcnt vmcnt(0)
    v_cmp_ne_u32 vcc, 0, v30
    s_nop 1
    s_mov_b32 s55, vcc_lo
    s_bitcmp1_b32 s55, 1
    s_cbranch_scc1 L_ok_1
    s_sleep 1
    s_sub_u32 s56, s56, 1
    s_cmp_lg_u32 s56, 0
    s_cbranch_scc1 L_spin_1
    s_branch L_done
L_ok_1:
    s_lshr_b32 s51, s85, 1
    s_add_u32 s50, s51, 0x1000
    buffer_load_dwordx4 v[96:99], v27, s[68:71], s51 offen offset:0 sc1
    buffer_load_dwordx4 v[100:103], v27, s[68:71], s51 offen offset:1024 sc1
    buffer_load_dwordx4 v[104:107], v27, s[68:71], s51 offen offset:2048 sc1
    buffer_load_dwordx4 v[108:111], v27, s[68:71], s51 offen offset:3072 sc1
    buffer_load_dwordx4 v[112:115], v27, s[68:71], s50 offen offset:0 sc1
    buffer_load_dwordx4 v[116:119], v27, s[68:71], s50 offen offset:1024 sc1
    buffer_load_dwordx4 v[120:123], v27, s[68:71], s50 offen offset:2048 sc1
    buffer_load_dwordx4 v[124:127], v27, s[68:71], s50 offen offset:3072 sc1
L_join:
    s_nop 1
    s_waitcnt vmcnt(8)
    v_mfma_f32_32x32x16_bf16 v[32:47], a[0:3], v[64:67], 0
    s_cmp_eq_u32 s96, 1
    s_cbranch_scc1 L_sk67_36
    s_add_u32 m0, s57, 0
    s_add_u32 s47, s89, 0x3000
    buffer_load_dwordx4 v27, s[64:67], s47 offen offset:0 sc1 lds
L_sk67_36:
    v_mfma_f32_32x32x16_bf16 v[48:63], a[4:7], v[64:67], 0
    v_mfma_f32_32x32x16_bf16 v[32:47], a[8:11], v[68:71], v[32:47]
    s_cmp_eq_u32 s96, 1
    s_cbranch_scc1 L_sk67_35
    s_add_u32 m0, s57, 0
    s_add_u32 s47, s89, 0x3000
    buffer_load_dwordx4 v27, s[64:67], s47 offen offset:1024 sc1 lds
L_sk67_35:
    v_mfma_f32_32x32x16_bf16 v[48:63], a[12:15], v[68:71], v[48:63]
    v_mfma_f32_32x32x16_bf16 v[32:47], a[16:19], v[72:75], v[32:47]
    s_cmp_eq_u32 s96, 1
    s_cbranch_scc1 L_sk67_34
    s_add_u32 m0, s57, 0
    s_add_u32 s47, s89, 0x3000
    buffer_load_dwordx4 v27, s[64:67], s47 offen offset:2048 sc1 lds
L_sk67_34:
    v_mfma_f32_32x32x16_bf16 v[48:63], a[20:23], v[72:75], v[48:63]
    v_mfma_f32_32x32x16_bf16 v[32:47], a[24:27], v[76:79], v[32:47]
    s_cmp_eq_u32 s96, 1
    s_cbranch_scc1 L_sk67_33
    s_add_u32 m0, s57, 0
    s_add_u32 s47, s89, 0x3000
    buffer_load_dwordx4 v27, s[64:67], s47 offen offset:3072 sc1 lds
L_sk67_33:
    v_mfma_f32_32x32x16_bf16 v[48:63], a[28:31], v[76:79], v[48:63]
    v_mfma_f32_32x32x16_bf16 v[32:47], a[32:35], v[80:83], v[32:47]
    s_cmp_eq_u32 s96, 1
    s_cbranch_scc1 L_sk67_32
    s_add_u32 m0, s46, 0
    s_add_u32 s47, s90, 0x0
    buffer_load_dwordx4 v27, s[64:67], s47 offen offset:0 sc1 lds
L_sk67_32:
    v_mfma_f32_32x32x16_bf16 v[48:63], a[36:39], v[80:83], v[48:63]
    v_mfma_f32_32x32x16_bf16 v[32:47], a[40:43], v[84:87], v[32:47]
    s_cmp_eq_u32 s96, 1
    s_cbranch_scc1 L_sk67_31
    s_add_u32 m0, s46, 0
    s_add_u32 s47, s90, 0x0
    buffer_load_dwordx4 v27, s[64:67], s47 offen offset:1024 sc1 lds
L_sk67_31:
    v_mfma_f32_32x32x16_bf16 v[48:63], a[44:47], v[84:87], v[48:63]
    v_mfma_f32_32x32x16_bf16 v[32:47], a[48:51], v[88:91], v[32:47]
    s_cmp_eq_u32 s96, 1
    s_cbranch_scc1 L_sk67_30
    s_add_u32 m0, s46, 0
    s_add_u32 s47, s90, 0x0
    buffer_load_dwordx4 v27, s[64:67], s47 offen offset:2048 sc1 lds
L_sk67_30:
    v_mfma_f32_32x32x16_bf16 v[48:63], a[52:55], v[88:91], v[48:63]
    v_mfma_f32_32x32x16_bf16 v[32:47], a[56:59], v[92:95], v[32:47]
    s_cmp_eq_u32 s96, 1
    s_cbranch_scc1 L_sk67_29
    s_add_u32 m0, s46, 0
    s_add_u32 s47, s90, 0x0
    buffer_load_dwordx4 v27, s[64:67], s47 offen offset:3072 sc1 lds
L_sk67_29:
    v_mfma_f32_32x32x16_bf16 v[48:63], a[60:63], v[92:95], v[48:63]
    s_bitcmp1_b32 s55, 2
    s_cbranch_scc1 L_ok_2
L_spin_2:
    buffer_load_dword v30, v29, s[76:79], 0 offen sc1
    s_waitcnt vmcnt(0)
    v_cmp_ne_u32 vcc, 0, v30
    s_nop 1
    s_mov_b32 s55, vcc_lo
    s_bitcmp1_b32 s55, 2
    s_cbranch_scc1 L_ok_2
    s_sleep 1
    s_sub_u32 s56, s56, 1
    s_cmp_lg_u32 s56, 0
    s_cbranch_scc1 L_spin_2
    s_branch L_done
L_ok_2:
    s_lshr_b32 s51, s86, 1
    s_add_u32 s50, s51, 0x1000
    buffer_load_dwordx4 v[64:67], v27, s[68:71], s51 offen offset:0 sc1
    buffer_load_dwordx4 v[68:71], v27, s[68:71], s51 offen offset:1024 sc1
    buffer_load_dwordx4 v[72:75], v27, s[68:71], s51 offen offset:2048 sc1
    buffer_load_dwordx4 v[76:79], v27, s[68:71], s51 offen offset:3072 sc1
    buffer_load_dwordx4 v[80:83], v27, s[68:71], s50 offen offset:0 sc1
    buffer_load_dwordx4 v[84:87], v27, s[68:71], s50 offen offset:1024 sc1
    buffer_load_dwordx4 v[88:91], v27, s[68:71], s50 offen offset:2048 sc1
    buffer_load_dwordx4 v[92:95], v27, s[68:71], s50 offen offset:3072 sc1
    s_waitcnt vmcnt(8)
    v_mfma_f32_32x32x16_bf16 v[32:47], a[64:67], v[96:99], v[32:47]
    s_cmp_eq_u32 s96, 1
    s_cbranch_scc1 L_sk67_28
    s_add_u32 m0, s46, 16384
    s_add_u32 s47, s90, 0x1000
    buffer_load_dwordx4 v27, s[64:67], s47 offen offset:0 sc1 lds
L_sk67_28:
    v_mfma_f32_32x32x16_bf16 v[48:63], a[68:71], v[96:99], v[48:63]
    s_cmp_eq_u32 s96, 1
    s_cbranch_scc1 L_sk67_27
    s_add_u32 m0, s46, 16384
    s_add_u32 s47, s90, 0x1000
    buffer_load_dwordx4 v27, s[64:67], s47 offen offset:1024 sc1 lds
L_sk67_27:
    v_mfma_f32_32x32x16_bf16 v[32:47], a[72:75], v[100:103], v[32:47]
    s_cmp_eq_u32 s96, 1
    s_cbranch_scc1 L_sk67_26
    s_add_u32 m0, s46, 16384
    s_add_u32 s47, s90, 0x1000
    buffer_load_dwordx4 v27, s[64:67], s47 offen offset:2048 sc1 lds
L_sk67_26:
    v_mfma_f32_32x32x16_bf16 v[48:63], a[76:79], v[100:103], v[48:63]
    s_cmp_eq_u32 s96, 1
    s_cbranch_scc1 L_sk67_25
    s_add_u32 m0, s46, 16384
    s_add_u32 s47, s90, 0x1000
    buffer_load_dwordx4 v27, s[64:67], s47 offen offset:3072 sc1 lds
L_sk67_25:
    v_mfma_f32_32x32x16_bf16 v[32:47], a[80:83], v[104:107], v[32:47]
    s_cmp_eq_u32 s96, 1
    s_cbranch_scc1 L_sk67_24
    s_add_u32 m0, s46, 65536
    s_add_u32 s47, s90, 0x2000
    buffer_load_dwordx4 v27, s[64:67], s47 offen offset:0 sc1 lds
L_sk67_24:
    v_mfma_f32_32x32x16_bf16 v[48:63], a[84:87], v[104:107], v[48:63]
    s_cmp_eq_u32 s96, 1
    s_cbranch_scc1 L_sk67_23
    s_add_u32 m0, s46, 65536
    s_add_u32 s47, s90, 0x2000
    buffer_load_dwordx4 v27, s[64:67], s47 offen offset:1024 sc1 lds
L_sk67_23:
    v_mfma_f32_32x32x16_bf16 v[32:47], a[88:91], v[108:111], v[32:47]
    s_cmp_eq_u32 s96, 1
    s_cbranch_scc1 L_sk67_22
    s_add_u32 m0, s46, 65536
    s_add_u32 s47, s90, 0x2000
    buffer_load_dwordx4 v27, s[64:67], s47 offen offset:2048 sc1 lds
L_sk67_22:
    v_mfma_f32_32x32x16_bf16 v[48:63], a[92:95], v[108:111], v[48:63]
    s_cmp_eq_u32 s96, 1
    s_cbranch_scc1 L_sk67_21
    s_add_u32 m0, s46, 65536
    s_add_u32 s47, s90, 0x2000
    buffer_load_dwordx4 v27, s[64:67], s47 offen offset:3072 sc1 lds
L_sk67_21:
    v_mfma_f32_32x32x16_bf16 v[32:47], a[96:99], v[112:115], v[32:47]
    s_cmp_eq_u32 s96, 1
    s_cbranch_scc1 L_sk67_20
    s_add_u32 m0, s46, 32768
    s_add_u32 s47, s90, 0x3000
    buffer_load_dwordx4 v27, s[64:67], s47 offen offset:0 sc1 lds
L_sk67_20:
    v_mfma_f32_32x32x16_bf16 v[48:63], a[100:103], v[112:115], v[48:63]
    s_cmp_eq_u32 s96, 1
    s_cbranch_scc1 L_sk67_19
    s_add_u32 m0, s46, 32768
    s_add_u32 s47, s90, 0x3000
    buffer_load_dwordx4 v27, s[64:67], s47 offen offset:1024 sc1 lds
L_sk67_19:
    v_mfma_f32_32x32x16_bf16 v[32:47], a[104:107], v[116:119], v[32:47]
    s_cmp_eq_u32 s96, 1
    s_cbranch_scc1 L_sk67_18
    s_add_u32 m0, s46, 32768
    s_add_u32 s47, s90, 0x3000
    buffer_load_dwordx4 v27, s[64:67], s47 offen offset:2048 sc1 lds
L_sk67_18:
    v_mfma_f32_32x32x16_bf16 v[48:63], a[108:111], v[116:119], v[48:63]
    s_cmp_eq_u32 s96, 1
    s_cbranch_scc1 L_sk67_17
    s_add_u32 m0, s46, 32768
    s_add_u32 s47, s90, 0x3000
    buffer_load_dwordx4 v27, s[64:67], s47 offen offset:3072 sc1 lds
L_sk67_17:
    v_mfma_f32_32x32x16_bf16 v[32:47], a[112:115], v[120:123], v[32:47]
    s_cmp_eq_u32 s96, 1
    s_cbranch_scc1 L_sk67_16
    s_add_u32 m0, s46, 81920
    s_add_u32 s47, s91, 0x0
    buffer_load_dwordx4 v27, s[64:67], s47 offen offset:0 sc1 lds
L_sk67_16:
    v_mfma_f32_32x32x16_bf16 v[48:63], a[116:119], v[120:123], v[48:63]
    s_cmp_eq_u32 s96, 1
    s_cbranch_scc1 L_sk67_15
    s_add_u32 m0, s46, 81920
    s_add_u32 s47, s91, 0x0
    buffer_load_dwordx4 v27, s[64:67], s47 offen offset:1024 sc1 lds
L_sk67_15:
    v_mfma_f32_32x32x16_bf16 v[32:47], a[120:123], v[124:127], v[32:47]
    s_cmp_eq_u32 s96, 1
    s_cbranch_scc1 L_sk67_14
    s_add_u32 m0, s46, 81920
    s_add_u32 s47, s91, 0x0
    buffer_load_dwordx4 v27, s[64:67], s47 offen offset:2048 sc1 lds
L_sk67_14:
    v_mfma_f32_32x32x16_bf16 v[48:63], a[124:127], v[124:127], v[48:63]
    s_cmp_eq_u32 s96, 1
    s_cbranch_scc1 L_sk67_13
    s_add_u32 m0, s46, 81920
    s_add_u32 s47, s91, 0x0
    buffer_load_dwordx4 v27, s[64:67], s47 offen offset:3072 sc1 lds
L_sk67_13:
    s_bitcmp1_b32 s55, 3
    s_cbranch_scc1 L_ok_3
L_spin_3:
    buffer_load_dword v30, v29, s[76:79], 0 offen sc1
    s_waitcnt vmcnt(0)
    v_cmp_ne_u32 vcc, 0, v30
    s_nop 1
    s_mov_b32 s55, vcc_lo
    s_bitcmp1_b32 s55, 3
    s_cbranch_scc1 L_ok_3
    s_sleep 1
    s_sub_u32 s56, s56, 1
    s_cmp_lg_u32 s56, 0
    s_cbranch_scc1 L_spin_3
    s_branch L_done
L_ok_3:
    s_lshr_b32 s51, s87, 1
    s_add_u32 s50, s51, 0x1000
    buffer_load_dwordx4 v[96:99], v27, s[68:71], s51 offen offset:0 sc1
    buffer_load_dwordx4 v[100:103], v27, s[68:71], s51 offen offset:1024 sc1
    buffer_load_dwordx4 v[104:107], v27, s[68:71], s51 offen offset:2048 sc1
    buffer_load_dwordx4 v[108:111], v27, s[68:71], s51 offen offset:3072 sc1
    buffer_load_dwordx4 v[112:115], v27, s[68:71], s50 offen offset:0 sc1
    buffer_load_dwordx4 v[116:119], v27, s[68:71], s50 offen offset:1024 sc1
    buffer_load_dwordx4 v[120:123], v27, s[68:71], s50 offen offset:2048 sc1
    buffer_load_dwordx4 v[124:127], v27, s[68:71], s50 offen offset:3072 sc1
    s_waitcnt vmcnt(8)
    v_mfma_f32_32x32x16_bf16 v[32:47], a[128:131], v[64:67], v[32:47]
    s_cmp_eq_u32 s96, 1
    s_cbranch_scc1 L_sk67_12
    s_add_u32 m0, s46, 49152
    s_add_u32 s47, s91, 0x1000
    buffer_load_dwordx4 v27, s[64:67], s47 offen offset:0 sc1 lds
L_sk67_12:
    v_mfma_f32_32x32x16_bf16 v[48:63], a[132:135], v[64:67], v[48:63]
    s_cmp_eq_u32 s96, 1
    s_cbranch_scc1 L_sk67_11
    s_add_u32 m0, s46, 49152
    s_add_u32 s47, s91, 0x1000
    buffer_load_dwordx4 v27, s[64:67], s47 offen offset:1024 sc1 lds
L_sk67_11:
    v_mfma_f32_32x32x16_bf16 v[32:47], a[136:139], v[68:71], v[32:47]
    s_cmp_eq_u32 s96, 1
    s_cbranch_scc1 L_sk67_10
    s_add_u32 m0, s46, 49152
    s_add_u32 s47, s91, 0x1000
    buffer_load_dwordx4 v27, s[64:67], s47 offen offset:2048 sc1 lds
L_sk67_10:
    v_mfma_f32_32x32x16_bf16 v[48:63], a[140:143], v[68:71], v[48:63]
    s_cmp_eq_u32 s96, 1
    s_cbranch_scc1 L_sk67_9
    s_add_u32 m0, s46, 49152
    s_add_u32 s47, s91, 0x1000
    buffer_load_dwordx4 v27, s[64:67], s47 offen offset:3072 sc1 lds
L_sk67_9:
    v_mfma_f32_32x32x16_bf16 v[32:47], a[144:147], v[72:75], v[32:47]
    s_cmp_eq_u32 s96, 1
    s_cbranch_scc1 L_sk67_8
    s_add_u32 m0, s46, 98304
    s_add_u32 s47, s91, 0x2000
    buffer_load_dwordx4 v27, s[64:67], s47 offen offset:0 sc1 lds
L_sk67_8:
    v_mfma_f32_32x32x16_bf16 v[48:63], a[148:151], v[72:75], v[48:63]
    s_cmp_eq_u32 s96, 1
    s_cbranch_scc1 L_sk67_7
    s_add_u32 m0, s46, 98304
    s_add_u32 s47, s91, 0x2000
    buffer_load_dwordx4 v27, s[64:67], s47 offen offset:1024 sc1 lds
L_sk67_7:
    v_mfma_f32_32x32x16_bf16 v[32:47], a[152:155], v[76:79], v[32:47]
    s_cmp_eq_u32 s96, 1
    s_cbranch_scc1 L_sk67_6
    s_add_u32 m0, s46, 98304
    s_add_u32 s47, s91, 0x2000
    buffer_load_dwordx4 v27, s[64:67], s47 offen offset:2048 sc1 lds
L_sk67_6:
    v_mfma_f32_32x32x16_bf16 v[48:63], a[156:159], v[76:79], v[48:63]
    s_cmp_eq_u32 s96, 1
    s_cbranch_scc1 L_sk67_5
    s_add_u32 m0, s46, 98304
    s_add_u32 s47, s91, 0x2000
    buffer_load_dwordx4 v27, s[64:67], s47 offen offset:3072 sc1 lds
L_sk67_5:
    v_mfma_f32_32x32x16_bf16 v[32:47], a[160:163], v[80:83], v[32:47]
    s_cmp_eq_u32 s96, 1
    s_cbranch_scc1 L_sk67_4
    s_add_u32 m0, s57, 4096
    s_add_u32 s47, s91, 0x3000
    buffer_load_dwordx4 v27, s[64:67], s47 offen offset:0 sc1 lds
L_sk67_4:
    v_mfma_f32_32x32x16_bf16 v[48:63], a[164:167], v[80:83], v[48:63]
    s_cmp_eq_u32 s96, 1
    s_cbranch_scc1 L_sk67_3
    s_add_u32 m0, s57, 4096
    s_add_u32 s47, s91, 0x3000
    buffer_load_dwordx4 v27, s[64:67], s47 offen offset:1024 sc1 lds
L_sk67_3:
    v_mfma_f32_32x32x16_bf16 v[32:47], a[168:171], v[84:87], v[32:47]
    s_cmp_eq_u32 s96, 1
    s_cbranch_scc1 L_sk67_2
    s_add_u32 m0, s57, 4096
    s_add_u32 s47, s91, 0x3000
    buffer_load_dwordx4 v27, s[64:67], s47 offen offset:2048 sc1 lds
L_sk67_2:
    v_mfma_f32_32x32x16_bf16 v[48:63], a[172:175], v[84:87], v[48:63]
    s_cmp_eq_u32 s96, 1
    s_cbranch_scc1 L_sk67_1
    s_add_u32 m0, s57, 4096
    s_add_u32 s47, s91, 0x3000
    buffer_load_dwordx4 v27, s[64:67], s47 offen offset:3072 sc1 lds
L_sk67_1:
    v_mfma_f32_32x32x16_bf16 v[32:47], a[176:179], v[88:91], v[32:47]
    v_mfma_f32_32x32x16_bf16 v[48:63], a[180:183], v[88:91], v[48:63]
    v_mfma_f32_32x32x16_bf16 v[32:47], a[184:187], v[92:95], v[32:47]
    v_mfma_f32_32x32x16_bf16 v[48:63], a[188:191], v[92:95], v[48:63]
    s_bitcmp1_b32 s55, 4
    s_cbranch_scc1 L_ok_4
L_spin_4:
    buffer_load_dword v30, v29, s[76:79], 0 offen sc1
    s_waitcnt vmcnt(0)
    v_cmp_ne_u32 vcc, 0, v30
    s_nop 1
    s_mov_b32 s55, vcc_lo
    s_bitcmp1_b32 s55, 4
    s_cbranch_scc1 L_ok_4
    s_sleep 1
    s_sub_u32 s56, s56, 1
    s_cmp_lg_u32 s56, 0
    s_cbranch_scc1 L_spin_4
    s_branch L_done
L_ok_4:
    s_lshr_b32 s51, s88, 1
    s_add_u32 s50, s51, 0x1000
    buffer_load_dwordx4 v[64:67], v27, s[68:71], s51 offen offset:0 sc1
    buffer_load_dwordx4 v[68:71], v27, s[68:71], s51 offen offset:1024 sc1
    buffer_load_dwordx4 v[72:75], v27, s[68:71], s51 offen offset:2048 sc1
    buffer_load_dwordx4 v[76:79], v27, s[68:71], s51 offen offset:3072 sc1
    buffer_load_dwordx4 v[80:83], v27, s[68:71], s50 offen offset:0 sc1
    buffer_load_dwordx4 v[84:87], v27, s[68:71], s50 offen offset:1024 sc1
    buffer_load_dwordx4 v[88:91], v27, s[68:71], s50 offen offset:2048 sc1
    buffer_load_dwordx4 v[92:95], v27, s[68:71], s50 offen offset:3072 sc1
    s_waitcnt vmcnt(8)
    v_mfma_f32_32x32x16_bf16 v[32:47], a[192:195], v[96:99], v[32:47]
    v_mfma_f32_32x32x16_bf16 v[48:63], a[196:199], v[96:99], v[48:63]
    v_mfma_f32_32x32x16_bf16 v[32:47], a[200:203], v[100:103], v[32:47]
    v_mfma_f32_32x32x16_bf16 v[48:63], a[204:207], v[100:103], v[48:63]
    v_mfma_f32_32x32x16_bf16 v[32:47], a[208:211], v[104:107], v[32:47]
    v_mfma_f32_32x32x16_bf16 v[48:63], a[212:215], v[104:107], v[48:63]
    v_mfma_f32_32x32x16_bf16 v[32:47], a[216:219], v[108:111], v[32:47]
    v_mfma_f32_32x32x16_bf16 v[48:63], a[220:223], v[108:111], v[48:63]
    v_mfma_f32_32x32x16_bf16 v[32:47], a[224:227], v[112:115], v[32:47]
    v_mfma_f32_32x32x16_bf16 v[48:63], a[228:231], v[112:115], v[48:63]
    v_mfma_f32_32x32x16_bf16 v[32:47], a[232:235], v[116:119], v[32:47]
    v_mfma_f32_32x32x16_bf16 v[48:63], a[236:239], v[116:119], v[48:63]
    v_mfma_f32_32x32x16_bf16 v[32:47], a[240:243], v[120:123], v[32:47]
    v_mfma_f32_32x32x16_bf16 v[48:63], a[244:247], v[120:123], v[48:63]
    v_mfma_f32_32x32x16_bf16 v[32:47], a[248:251], v[124:127], v[32:47]
    v_mfma_f32_32x32x16_bf16 v[48:63], a[252:255], v[124:127], v[48:63]
    s_bitcmp1_b32 s55, 5
    s_cbranch_scc1 L_ok_5
L_spin_5:
    buffer_load_dword v30, v29, s[76:79], 0 offen sc1
    s_waitcnt vmcnt(0)
    v_cmp_ne_u32 vcc, 0, v30
    s_nop 1
    s_mov_b32 s55, vcc_lo
    s_bitcmp1_b32 s55, 5
    s_cbranch_scc1 L_ok_5
    s_sleep 1
    s_sub_u32 s56, s56, 1
    s_cmp_lg_u32 s56, 0
    s_cbranch_scc1 L_spin_5
    s_branch L_done
L_ok_5:
    s_lshr_b32 s51, s89, 1
    s_add_u32 s50, s51, 0x1000
    buffer_load_dwordx4 v[96:99], v27, s[68:71], s51 offen offset:0 sc1
    buffer_load_dwordx4 v[100:103], v27, s[68:71], s51 offen offset:1024 sc1
    buffer_load_dwordx4 v[104:107], v27, s[68:71], s51 offen offset:2048 sc1
    buffer_load_dwordx4 v[108:111], v27, s[68:71], s51 offen offset:3072 sc1
    buffer_load_dwordx4 v[112:115], v27, s[68:71], s50 offen offset:0 sc1
    buffer_load_dwordx4 v[116:119], v27, s[68:71], s50 offen offset:1024 sc1
    buffer_load_dwordx4 v[120:123], v27, s[68:71], s50 offen offset:2048 sc1
    buffer_load_dwordx4 v[124:127], v27, s[68:71], s50 offen offset:3072 sc1
    s_waitcnt vmcnt(16)
    ds_read_b128 v[240:243], v24 offset:0
    ds_read_b128 v[244:247], v24 offset:1024
    ds_read_b128 v[248:251], v24 offset:2048
    ds_read_b128 v[252:255], v24 offset:3072
    ds_read_b128 a[0:3], v1 offset:0
    ds_read_b128 a[4:7], v1 offset:1024
    ds_read_b128 a[8:11], v1 offset:2048
    ds_read_b128 a[12:15], v1 offset:3072
    ds_read_b128 a[16:19], v1 offset:16384
    ds_read_b128 a[20:23], v1 offset:17408
    ds_read_b128 a[24:27], v1 offset:18432
    ds_read_b128 a[28:31], v1 offset:19456
    ds_read_b128 a[32:35], v2 offset:0
    ds_read_b128 a[36:39], v2 offset:1024
    ds_read_b128 a[40:43], v2 offset:2048
    ds_read_b128 a[44:47], v2 offset:3072
    ds_read_b128 a[48:51], v1 offset:32768
    ds_read_b128 a[52:55], v1 offset:33792
    ds_read_b128 a[56:59], v1 offset:34816
    ds_read_b128 a[60:63], v1 offset:35840
    ds_read_b128 a[64:67], v2 offset:16384
    ds_read_b128 a[68:71], v2 offset:17408
    ds_read_b128 a[72:75], v2 offset:18432
    ds_read_b128 a[76:79], v2 offset:19456
    ds_read_b128 a[80:83], v1 offset:49152
    ds_read_b128 a[84:87], v1 offset:50176
    ds_read_b128 a[88:91], v1 offset:51200
    ds_read_b128 a[92:95], v1 offset:52224
    ds_read_b128 a[96:99], v2 offset:32768
    ds_read_b128 a[100:103], v2 offset:33792
    ds_read_b128 a[104:107], v2 offset:34816
    ds_read_b128 a[108:111], v2 offset:35840
    ds_read_b128 a[112:115], v24 offset:4096
    ds_read_b128 a[116:119], v24 offset:5120
    ds_read_b128 a[120:123], v24 offset:6144
    ds_read_b128 a[124:127], v24 offset:7168
    s_waitcnt vmcnt(8)
    v_mfma_f32_32x32x16_bf16 v[32:47], v[128:131], v[64:67], v[32:47]
    v_mfma_f32_32x32x16_bf16 v[48:63], v[132:135], v[64:67], v[48:63]
    v_mfma_f32_32x32x16_bf16 v[32:47], v[136:139], v[68:71], v[32:47]
    v_mfma_f32_32x32x16_bf16 v[48:63], v[140:143], v[68:71], v[48:63]
    v_mfma_f32_32x32x16_bf16 v[32:47], v[144:147], v[72:75], v[32:47]
    v_mfma_f32_32x32x16_bf16 v[48:63], v[148:151], v[72:75], v[48:63]
    v_mfma_f32_32x32x16_bf16 v[32:47], v[152:155], v[76:79], v[32:47]
    v_mfma_f32_32x32x16_bf16 v[48:63], v[156:159], v[76:79], v[48:63]
    v_mfma_f32_32x32x16_bf16 v[32:47], v[160:163], v[80:83], v[32:47]
    v_mfma_f32_32x32x16_bf16 v[48:63], v[164:167], v[80:83], v[48:63]
    v_mfma_f32_32x32x16_bf16 v[32:47], v[168:171], v[84:87], v[32:47]
    v_mfma_f32_32x32x16_bf16 v[48:63], v[172:175], v[84:87], v[48:63]
    v_mfma_f32_32x32x16_bf16 v[32:47], v[176:179], v[88:91], v[32:47]
    v_mfma_f32_32x32x16_bf16 v[48:63], v[180:183], v[88:91], v[48:63]
    v_mfma_f32_32x32x16_bf16 v[32:47], v[184:187], v[92:95], v[32:47]
    v_mfma_f32_32x32x16_bf16 v[48:63], v[188:191], v[92:95], v[48:63]
    s_bitcmp1_b32 s55, 6
    s_cbranch_scc1 L_ok_6
L_spin_6:
    buffer_load_dword v30, v29, s[76:79], 0 offen sc1
    s_waitcnt vmcnt(0)
    v_cmp_ne_u32 vcc, 0, v30
    s_nop 1
    s_mov_b32 s55, vcc_lo
    s_bitcmp1_b32 s55, 6
    s_cbranch_scc1 L_ok_6
    s_sleep 1
    s_sub_u32 s56, s56, 1
    s_cmp_lg_u32 s56, 0
    s_cbranch_scc1 L_spin_6
    s_branch L_done
L_ok_6:
    s_lshr_b32 s51, s90, 1
    s_add_u32 s50, s51, 0x1000
    buffer_load_dwordx4 v[64:67], v27, s[68:71], s51 offen offset:0 sc1
    buffer_load_dwordx4 v[68:71], v27, s[68:71], s51 offen offset:1024 sc1
    buffer_load_dwordx4 v[72:75], v27, s[68:71], s51 offen offset:2048 sc1
    buffer_load_dwordx4 v[76:79], v27, s[68:71], s51 offen offset:3072 sc1
    buffer_load_dwordx4 v[80:83], v27, s[68:71], s50 offen offset:0 sc1
    buffer_load_dwordx4 v[84:87], v27, s[68:71], s50 offen offset:1024 sc1
    buffer_load_dwordx4 v[88:91], v27, s[68:71], s50 offen offset:2048 sc1
    buffer_load_dwordx4 v[92:95], v27, s[68:71], s50 offen offset:3072 sc1
    s_waitcnt vmcnt(8)
    v_mfma_f32_32x32x16_bf16 v[32:47], v[192:195], v[96:99], v[32:47]
    v_mfma_f32_32x32x16_bf16 v[48:63], v[196:199], v[96:99], v[48:63]
    v_mfma_f32_32x32x16_bf16 v[32:47], v[200:203], v[100:103], v[32:47]
    v_mfma_f32_32x32x16_bf16 v[48:63], v[204:207], v[100:103], v[48:63]
    v_mfma_f32_32x32x16_bf16 v[32:47], v[208:211], v[104:107], v[32:47]
    v_mfma_f32_32x32x16_bf16 v[48:63], v[212:215], v[104:107], v[48:63]
    v_mfma_f32_32x32x16_bf16 v[32:47], v[216:219], v[108:111], v[32:47]
    v_mfma_f32_32x32x16_bf16 v[48:63], v[220:223], v[108:111], v[48:63]
    v_mfma_f32_32x32x16_bf16 v[32:47], v[224:227], v[112:115], v[32:47]
    v_mfma_f32_32x32x16_bf16 v[48:63], v[228:231], v[112:115], v[48:63]
    v_mfma_f32_32x32x16_bf16 v[32:47], v[232:235], v[116:119], v[32:47]
    v_mfma_f32_32x32x16_bf16 v[48:63], v[236:239], v[116:119], v[48:63]
    s_waitcnt lgkmcnt(15)
    v_mfma_f32_32x32x16_bf16 v[32:47], v[240:243], v[120:123], v[32:47]
    v_mfma_f32_32x32x16_bf16 v[48:63], v[244:247], v[120:123], v[48:63]
    v_mfma_f32_32x32x16_bf16 v[32:47], v[248:251], v[124:127], v[32:47]
    v_mfma_f32_32x32x16_bf16 v[48:63], v[252:255], v[124:127], v[48:63]
    s_bitcmp1_b32 s55, 7
    s_cbranch_scc1 L_ok_7
L_spin_7:
    buffer_load_dword v30, v29, s[76:79], 0 offen sc1
    s_waitcnt vmcnt(0)
    v_cmp_ne_u32 vcc, 0, v30
    s_nop 1
    s_mov_b32 s55, vcc_lo
    s_bitcmp1_b32 s55, 7
    s_cbranch_scc1 L_ok_7
    s_sleep 1
    s_sub_u32 s56, s56, 1
    s_cmp_lg_u32 s56, 0
    s_cbranch_scc1 L_spin_7
    s_branch L_done
L_ok_7:
    s_lshr_b32 s51, s91, 1
    s_add_u32 s50, s51, 0x1000
    buffer_load_dwordx4 v[96:99], v27, s[68:71], s51 offen offset:0 sc1
    buffer_load_dwordx4 v[100:103], v27, s[68:71], s51 offen offset:1024 sc1
    buffer_load_dwordx4 v[104:107], v27, s[68:71], s51 offen offset:2048 sc1
    buffer_load_dwordx4 v[108:111], v27, s[68:71], s51 offen offset:3072 sc1
    buffer_load_dwordx4 v[112:115], v27, s[68:71], s50 offen offset:0 sc1
    buffer_load_dwordx4 v[116:119], v27, s[68:71], s50 offen offset:1024 sc1
    buffer_load_dwordx4 v[120:123], v27, s[68:71], s50 offen offset:2048 sc1
    buffer_load_dwordx4 v[124:127], v27, s[68:71], s50 offen offset:3072 sc1
    s_waitcnt vmcnt(8)
    v_mfma_f32_32x32x16_bf16 v[32:47], a[0:3], v[64:67], v[32:47]
    v_mfma_f32_32x32x16_bf16 v[48:63], a[4:7], v[64:67], v[48:63]
    v_mfma_f32_32x32x16_bf16 v[32:47], a[8:11], v[68:71], v[32:47]
    v_mfma_f32_32x32x16_bf16 v[48:63], a[12:15], v[68:71], v[48:63]
    v_mfma_f32_32x32x16_bf16 v[32:47], a[16:19], v[72:75], v[32:47]
    v_mfma_f32_32x32x16_bf16 v[48:63], a[20:23], v[72:75], v[48:63]
    v_mfma_f32_32x32x16_bf16 v[32:47], a[24:27], v[76:79], v[32:47]
    v_mfma_f32_32x32x16_bf16 v[48:63], a[28:31], v[76:79], v[48:63]
    v_mfma_f32_32x32x16_bf16 v[32:47], a[32:35], v[80:83], v[32:47]
    v_mfma_f32_32x32x16_bf16 v[48:63], a[36:39], v[80:83], v[48:63]
    v_mfma_f32_32x32x16_bf16 v[32:47], a[40:43], v[84:87], v[32:47]
    v_mfma_f32_32x32x16_bf16 v[48:63], a[44:47], v[84:87], v[48:63]
    v_mfma_f32_32x32x16_bf16 v[32:47], a[48:51], v[88:91], v[32:47]
    v_mfma_f32_32x32x16_bf16 v[48:63], a[52:55], v[88:91], v[48:63]
    v_mfma_f32_32x32x16_bf16 v[32:47], a[56:59], v[92:95], v[32:47]
    v_mfma_f32_32x32x16_bf16 v[48:63], a[60:63], v[92:95], v[48:63]
    s_waitcnt vmcnt(0)
    v_mfma_f32_32x32x16_bf16 v[32:47], a[64:67], v[96:99], v[32:47]
    s_waitcnt lgkmcnt(14)
    v_mfma_f32_32x32x16_bf16 v[48:63], a[68:71], v[96:99], v[48:63]
    s_waitcnt lgkmcnt(13)
    v_mfma_f32_32x32x16_bf16 v[32:47], a[72:75], v[100:103], v[32:47]
    s_waitcnt lgkmcnt(12)
    v_mfma_f32_32x32x16_bf16 v[48:63], a[76:79], v[100:103], v[48:63]
    s_waitcnt lgkmcnt(11)
    v_mfma_f32_32x32x16_bf16 v[32:47], a[80:83], v[104:107], v[32:47]
    s_waitcnt lgkmcnt(10)
    v_mfma_f32_32x32x16_bf16 v[48:63], a[84:87], v[104:107], v[48:63]
    s_waitcnt lgkmcnt(9)
    v_mfma_f32_32x32x16_bf16 v[32:47], a[88:91], v[108:111], v[32:47]
    s_waitcnt lgkmcnt(8)
    v_mfma_f32_32x32x16_bf16 v[48:63], a[92:95], v[108:111], v[48:63]
    s_waitcnt lgkmcnt(7)
    v_mfma_f32_32x32x16_bf16 v[32:47], a[96:99], v[112:115], v[32:47]
    s_waitcnt lgkmcnt(6)
    v_mfma_f32_32x32x16_bf16 v[48:63], a[100:103], v[112:115], v[48:63]
    s_waitcnt lgkmcnt(5)
    v_mfma_f32_32x32x16_bf16 v[32:47], a[104:107], v[116:119], v[32:47]
    s_waitcnt lgkmcnt(4)
    v_mfma_f32_32x32x16_bf16 v[48:63], a[108:111], v[116:119], v[48:63]
    s_waitcnt lgkmcnt(3)
    v_mfma_f32_32x32x16_bf16 v[32:47], a[112:115], v[120:123], v[32:47]
    s_waitcnt lgkmcnt(2)
    v_mfma_f32_32x32x16_bf16 v[48:63], a[116:119], v[120:123], v[48:63]
    s_waitcnt lgkmcnt(1)
    v_mfma_f32_32x32x16_bf16 v[32:47], a[120:123], v[124:127], v[32:47]
    s_waitcnt lgkmcnt(0)
    v_mfma_f32_32x32x16_bf16 v[48:63], a[124:127], v[124:127], v[48:63]
    v_add_u32 v7, s57, v27
    s_nop 8
    ds_write_b128 v7, v[32:35] offset:0
    ds_write_b128 v7, v[36:39] offset:1024
    ds_write_b128 v7, v[40:43] offset:2048
    ds_write_b128 v7, v[44:47] offset:3072
    ds_write_b128 v7, v[48:51] offset:4096
    ds_write_b128 v7, v[52:55] offset:5120
    ds_write_b128 v7, v[56:59] offset:6144
    ds_write_b128 v7, v[60:63] offset:7168
    s_waitcnt lgkmcnt(0)
    s_barrier
    s_lshl_b32 s47, s42, 11
    s_add_u32 s47, s47, 0x20000
    v_add_u32 v8, s47, v27
    ds_read_b128 v[64:67], v8 offset:0
    ds_read_b128 v[68:71], v8 offset:8192
    ds_read_b128 v[72:75], v8 offset:16384
    ds_read_b128 v[76:79], v8 offset:24576
    ds_read_b128 v[80:83], v8 offset:1024
    ds_read_b128 v[84:87], v8 offset:9216
    ds_read_b128 v[88:91], v8 offset:17408
    ds_read_b128 v[92:95], v8 offset:25600
    v_bfe_u32 v9, v27, 4, 5
    v_lshlrev_b32 v9, 10, v9
    v_lshrrev_b32 v10, 9, v27
    v_lshl_add_u32 v9, v10, 3, v9
    s_lshl_b32 s47, s42, 5
    v_add_u32 v9, s47, v9
    s_waitcnt lgkmcnt(6)
    v_add_f32 v64, v64, v68
    s_waitcnt lgkmcnt(4)
    v_add_f32 v72, v72, v76
    v_add_f32 v64, v64, v72
    v_add_f32 v65, v65, v69
    v_add_f32 v73, v73, v77
    v_add_f32 v65, v65, v73
    v_add_f32 v66, v66, v70
    v_add_f32 v74, v74, v78
    v_add_f32 v66, v66, v74
    v_add_f32 v67, v67, v71
    v_add_f32 v75, v75, v79
    v_add_f32 v67, v67, v75
    v_cvt_pk_bf16_f32 v12, v64, v65
    v_cvt_pk_bf16_f32 v13, v66, v67
    buffer_store_dwordx2 v[12:13], v9, s[72:75], 0 offen offset:0
    s_waitcnt lgkmcnt(2)
    v_add_f32 v80, v80, v84
    s_waitcnt lgkmcnt(0)
    v_add_f32 v88, v88, v92
    v_add_f32 v80, v80, v88
    v_add_f32 v81, v81, v85
    v_add_f32 v89, v89, v93
    v_add_f32 v81, v81, v89
    v_add_f32 v82, v82, v86
    v_add_f32 v90, v90, v94
    v_add_f32 v82, v82, v90
    v_add_f32 v83, v83, v87
    v_add_f32 v91, v91, v95
    v_add_f32 v83, v83, v91
    v_cvt_pk_bf16_f32 v14, v80, v81
    v_cvt_pk_bf16_f32 v15, v82, v83
    buffer_store_dwordx2 v[14:15], v9, s[72:75], 0 offen offset:16
L_done:
    s_endpgm
L_rare_m0:
    s_nop 15
    v_mov_b32 v21, v20
    s_nop 1
    v_permlane32_swap_b32 v20, v21
    v_max_f32 v20, v20, v21
    v_max_f32 v20, 0, v20
    v_exp_f32 v22, -v20
    v_sub_f32 v160, v160, v20
    v_sub_f32 v161, v161, v20
    v_sub_f32 v162, v162, v20
    v_sub_f32 v163, v163, v20
    v_sub_f32 v164, v164, v20
    v_sub_f32 v165, v165, v20
    v_sub_f32 v166, v166, v20
    v_sub_f32 v167, v167, v20
    v_sub_f32 v168, v168, v20
    v_sub_f32 v169, v169, v20
    v_sub_f32 v170, v170, v20
    v_sub_f32 v171, v171, v20
    v_sub_f32 v172, v172, v20
    v_sub_f32 v173, v173, v20
    v_sub_f32 v174, v174, v20
    v_sub_f32 v175, v175, v20
    v_sub_f32 v176, v176, v20
    v_sub_f32 v177, v177, v20
    v_sub_f32 v178, v178, v20
    v_sub_f32 v179, v179, v20
    v_sub_f32 v180, v180, v20
    v_sub_f32 v181, v181, v20
    v_sub_f32 v182, v182, v20
    v_sub_f32 v183, v183, v20
    v_sub_f32 v184, v184, v20
    v_sub_f32 v185, v185, v20
    v_sub_f32 v186, v186, v20
    v_sub_f32 v187, v187, v20
    v_sub_f32 v188, v188, v20
    v_sub_f32 v189, v189, v20
    v_sub_f32 v190, v190, v20
    v_sub_f32 v191, v191, v20
    v_sub_f32 v192, v192, v20
    v_sub_f32 v193, v193, v20
    v_sub_f32 v194, v194, v20
    v_sub_f32 v195, v195, v20
    v_sub_f32 v196, v196, v20
    v_sub_f32 v197, v197, v20
    v_sub_f32 v198, v198, v20
    v_sub_f32 v199, v199, v20
    v_sub_f32 v200, v200, v20
    v_sub_f32 v201, v201, v20
    v_sub_f32 v202, v202, v20
    v_sub_f32 v203, v203, v20
    v_sub_f32 v204, v204, v20
    v_sub_f32 v205, v205, v20
    v_sub_f32 v206, v206, v20
    v_sub_f32 v207, v207, v20
    v_mul_f32 v64, v64, v22
    v_mul_f32 v65, v65, v22
    v_mul_f32 v66, v66, v22
    v_mul_f32 v67, v67, v22
    v_mul_f32 v68, v68, v22
    v_mul_f32 v69, v69, v22
    v_mul_f32 v70, v70, v22
    v_mul_f32 v71, v71, v22
    v_mul_f32 v72, v72, v22
    v_mul_f32 v73, v73, v22
    v_mul_f32 v74, v74, v22
    v_mul_f32 v75, v75, v22
    v_mul_f32 v76, v76, v22
    v_mul_f32 v77, v77, v22
    v_mul_f32 v78, v78, v22
    v_mul_f32 v79, v79, v22
    v_mul_f32 v80, v80, v22
    v_mul_f32 v81, v81, v22
    v_mul_f32 v82, v82, v22
    v_mul_f32 v83, v83, v22
    v_mul_f32 v84, v84, v22
    v_mul_f32 v85, v85, v22
    v_mul_f32 v86, v86, v22
    v_mul_f32 v87, v87, v22
    v_mul_f32 v88, v88, v22
    v_mul_f32 v89, v89, v22
    v_mul_f32 v90, v90, v22
    v_mul_f32 v91, v91, v22
    v_mul_f32 v92, v92, v22
    v_mul_f32 v93, v93, v22
    v_mul_f32 v94, v94, v22
    v_mul_f32 v95, v95, v22
    v_mul_f32 v96, v96, v22
    v_mul_f32 v97, v97, v22
    v_mul_f32 v98, v98, v22
    v_mul_f32 v99, v99, v22
    v_mul_f32 v100, v100, v22
    v_mul_f32 v101, v101, v22
    v_mul_f32 v102, v102, v22
    v_mul_f32 v103, v103, v22
    v_mul_f32 v104, v104, v22
    v_mul_f32 v105, v105, v22
    v_mul_f32 v106, v106, v22
    v_mul_f32 v107, v107, v22
    v_mul_f32 v108, v108, v22
    v_mul_f32 v109, v109, v22
    v_mul_f32 v110, v110, v22
    v_mul_f32 v111, v111, v22
    v_mul_f32 v112, v112, v22
    v_mul_f32 v113, v113, v22
    v_mul_f32 v114, v114, v22
    v_mul_f32 v115, v115, v22
    v_mul_f32 v116, v116, v22
    v_mul_f32 v117, v117, v22
    v_mul_f32 v118, v118, v22
    v_mul_f32 v119, v119, v22
    v_mul_f32 v120, v120, v22
    v_mul_f32 v121, v121, v22
    v_mul_f32 v122, v122, v22
    v_mul_f32 v123, v123, v22
    v_mul_f32 v124, v124, v22
    v_mul_f32 v125, v125, v22
    v_mul_f32 v126, v126, v22
    v_mul_f32 v127, v127, v22
    v_mul_f32 v18, v18, v22
    v_mul_f32 v19, v19, v22
    s_nop 3
    s_branch L_ret_m0
L_rare_m1:
    s_nop 15
    v_mov_b32 v21, v20
    s_nop 1
    v_permlane32_swap_b32 v20, v21
    v_max_f32 v20, v20, v21
    v_max_f32 v20, 0, v20
    v_exp_f32 v22, -v20
    v_sub_f32 v128, v128, v20
    v_sub_f32 v129, v129, v20
    v_sub_f32 v130, v130, v20
    v_sub_f32 v131, v131, v20
    v_sub_f32 v132, v132, v20
    v_sub_f32 v133, v133, v20
    v_sub_f32 v134, v134, v20
    v_sub_f32 v135, v135, v20
    v_sub_f32 v136, v136, v20
    v_sub_f32 v137, v137, v20
    v_sub_f32 v138, v138, v20
    v_sub_f32 v139, v139, v20
    v_sub_f32 v140, v140, v20
    v_sub_f32 v141, v141, v20
    v_sub_f32 v142, v142, v20
    v_sub_f32 v143, v143, v20
    v_sub_f32 v144, v144, v20
    v_sub_f32 v145, v145, v20
    v_sub_f32 v146, v146, v20
    v_sub_f32 v147, v147, v20
    v_sub_f32 v148, v148, v20
    v_sub_f32 v149, v149, v20
    v_sub_f32 v150, v150, v20
    v_sub_f32 v151, v151, v20
    v_sub_f32 v152, v152, v20
    v_sub_f32 v153, v153, v20
    v_sub_f32 v154, v154, v20
    v_sub_f32 v155, v155, v20
    v_sub_f32 v156, v156, v20
    v_sub_f32 v157, v157, v20
    v_sub_f32 v158, v158, v20
    v_sub_f32 v159, v159, v20
    v_sub_f32 v192, v192, v20
    v_sub_f32 v193, v193, v20
    v_sub_f32 v194, v194, v20
    v_sub_f32 v195, v195, v20
    v_sub_f32 v196, v196, v20
    v_sub_f32 v197, v197, v20
    v_sub_f32 v198, v198, v20
    v_sub_f32 v199, v199, v20
    v_sub_f32 v200, v200, v20
    v_sub_f32 v201, v201, v20
    v_sub_f32 v202, v202, v20
    v_sub_f32 v203, v203, v20
    v_sub_f32 v204, v204, v20
    v_sub_f32 v205, v205, v20
    v_sub_f32 v206, v206, v20
    v_sub_f32 v207, v207, v20
    v_mul_f32 v64, v64, v22
    v_mul_f32 v65, v65, v22
    v_mul_f32 v66, v66, v22
    v_mul_f32 v67, v67, v22
    v_mul_f32 v68, v68, v22
    v_mul_f32 v69, v69, v22
    v_mul_f32 v70, v70, v22
    v_mul_f32 v71, v71, v22
    v_mul_f32 v72, v72, v22
    v_mul_f32 v73, v73, v22
    v_mul_f32 v74, v74, v22
    v_mul_f32 v75, v75, v22
    v_mul_f32 v76, v76, v22
    v_mul_f32 v77, v77, v22
    v_mul_f32 v78, v78, v22
    v_mul_f32 v79, v79, v22
    v_mul_f32 v80, v80, v22
    v_mul_f32 v81, v81, v22
    v_mul_f32 v82, v82, v22
    v_mul_f32 v83, v83, v22
    v_mul_f32 v84, v84, v22
    v_mul_f32 v85, v85, v22
    v_mul_f32 v86, v86, v22
    v_mul_f32 v87, v87, v22
    v_mul_f32 v88, v88, v22
    v_mul_f32 v89, v89, v22
    v_mul_f32 v90, v90, v22
    v_mul_f32 v91, v91, v22
    v_mul_f32 v92, v92, v22
    v_mul_f32 v93, v93, v22
    v_mul_f32 v94, v94, v22
    v_mul_f32 v95, v95, v22
    v_mul_f32 v96, v96, v22
    v_mul_f32 v97, v97, v22
    v_mul_f32 v98, v98, v22
    v_mul_f32 v99, v99, v22
    v_mul_f32 v100, v100, v22
    v_mul_f32 v101, v101, v22
    v_mul_f32 v102, v102, v22
    v_mul_f32 v103, v103, v22
    v_mul_f32 v104, v104, v22
    v_mul_f32 v105, v105, v22
    v_mul_f32 v106, v106, v22
    v_mul_f32 v107, v107, v22
    v_mul_f32 v108, v108, v22
    v_mul_f32 v109, v109, v22
    v_mul_f32 v110, v110, v22
    v_mul_f32 v111, v111, v22
    v_mul_f32 v112, v112, v22
    v_mul_f32 v113, v113, v22
    v_mul_f32 v114, v114, v22
    v_mul_f32 v115, v115, v22
    v_mul_f32 v116, v116, v22
    v_mul_f32 v117, v117, v22
    v_mul_f32 v118, v118, v22
    v_mul_f32 v119, v119, v22
    v_mul_f32 v120, v120, v22
    v_mul_f32 v121, v121, v22
    v_mul_f32 v122, v122, v22
    v_mul_f32 v123, v123, v22
    v_mul_f32 v124, v124, v22
    v_mul_f32 v125, v125, v22
    v_mul_f32 v126, v126, v22
    v_mul_f32 v127, v127, v22
    v_mul_f32 v18, v18, v22
    v_mul_f32 v19, v19, v22
    s_nop 3
    s_branch L_ret_m1
L_rare_m2:
    s_nop 15
    v_mov_b32 v21, v20
    s_nop 1
    v_permlane32_swap_b32 v20, v21
    v_max_f32 v20, v20, v21
    v_max_f32 v20, 0, v20
    v_exp_f32 v22, -v20
    v_sub_f32 v160, v160, v20
    v_sub_f32 v161, v161, v20
    v_sub_f32 v162, v162, v20
    v_sub_f32 v163, v163, v20
    v_sub_f32 v164, v164, v20
    v_sub_f32 v165, v165, v20
    v_sub_f32 v166, v166, v20
    v_sub_f32 v167, v167, v20
    v_sub_f32 v168, v168, v20
    v_sub_f32 v169, v169, v20
    v_sub_f32 v170, v170, v20
    v_sub_f32 v171, v171, v20
    v_sub_f32 v172, v172, v20
    v_sub_f32 v173, v173, v20
    v_sub_f32 v174, v174, v20
    v_sub_f32 v175, v175, v20
    v_sub_f32 v176, v176, v20
    v_sub_f32 v177, v177, v20
    v_sub_f32 v178, v178, v20
    v_sub_f32 v179, v179, v20
    v_sub_f32 v180, v180, v20
    v_sub_f32 v181, v181, v20
    v_sub_f32 v182, v182, v20
    v_sub_f32 v183, v183, v20
    v_sub_f32 v184, v184, v20
    v_sub_f32 v185, v185, v20
    v_sub_f32 v186, v186, v20
    v_sub_f32 v187, v187, v20
    v_sub_f32 v188, v188, v20
    v_sub_f32 v189, v189, v20
    v_sub_f32 v190, v190, v20
    v_sub_f32 v191, v191, v20
    v_sub_f32 v192, v192, v20
    v_sub_f32 v193, v193, v20
    v_sub_f32 v194, v194, v20
    v_sub_f32 v195, v195, v20
    v_sub_f32 v196, v196, v20
    v_sub_f32 v197, v197, v20
    v_sub_f32 v198, v198, v20
    v_sub_f32 v199, v199, v20
    v_sub_f32 v200, v200, v20
    v_sub_f32 v201, v201, v20
    v_sub_f32 v202, v202, v20
    v_sub_f32 v203, v203, v20
    v_sub_f32 v204, v204, v20
    v_sub_f32 v205, v205, v20
    v_sub_f32 v206, v206, v20
    v_sub_f32 v207, v207, v20
    v_mul_f32 v64, v64, v22
    v_mul_f32 v65, v65, v22
    v_mul_f32 v66, v66, v22
    v_mul_f32 v67, v67, v22
    v_mul_f32 v68, v68, v22
    v_mul_f32 v69, v69, v22
    v_mul_f32 v70, v70, v22
    v_mul_f32 v71, v71, v22
    v_mul_f32 v72, v72, v22
    v_mul_f32 v73, v73, v22
    v_mul_f32 v74, v74, v22
    v_mul_f32 v75, v75, v22
    v_mul_f32 v76, v76, v22
    v_mul_f32 v77, v77, v22
    v_mul_f32 v78, v78, v22
    v_mul_f32 v79, v79, v22
    v_mul_f32 v80, v80, v22
    v_mul_f32 v81, v81, v22
    v_mul_f32 v82, v82, v22
    v_mul_f32 v83, v83, v22
    v_mul_f32 v84, v84, v22
    v_mul_f32 v85, v85, v22
    v_mul_f32 v86, v86, v22
    v_mul_f32 v87, v87, v22
    v_mul_f32 v88, v88, v22
    v_mul_f32 v89, v89, v22
    v_mul_f32 v90, v90, v22
    v_mul_f32 v91, v91, v22
    v_mul_f32 v92, v92, v22
    v_mul_f32 v93, v93, v22
    v_mul_f32 v94, v94, v22
    v_mul_f32 v95, v95, v22
    v_mul_f32 v96, v96, v22
    v_mul_f32 v97, v97, v22
    v_mul_f32 v98, v98, v22
    v_mul_f32 v99, v99, v22
    v_mul_f32 v100, v100, v22
    v_mul_f32 v101, v101, v22
    v_mul_f32 v102, v102, v22
    v_mul_f32 v103, v103, v22
    v_mul_f32 v104, v104, v22
    v_mul_f32 v105, v105, v22
    v_mul_f32 v106, v106, v22
    v_mul_f32 v107, v107, v22
    v_mul_f32 v108, v108, v22
    v_mul_f32 v109, v109, v22
    v_mul_f32 v110, v110, v22
    v_mul_f32 v111, v111, v22
    v_mul_f32 v112, v112, v22
    v_mul_f32 v113, v113, v22
    v_mul_f32 v114, v114, v22
    v_mul_f32 v115, v115, v22
    v_mul_f32 v116, v116, v22
    v_mul_f32 v117, v117, v22
    v_mul_f32 v118, v118, v22
    v_mul_f32 v119, v119, v22
    v_mul_f32 v120, v120, v22
    v_mul_f32 v121, v121, v22
    v_mul_f32 v122, v122, v22
    v_mul_f32 v123, v123, v22
    v_mul_f32 v124, v124, v22
    v_mul_f32 v125, v125, v22
    v_mul_f32 v126, v126, v22
    v_mul_f32 v127, v127, v22
    v_mul_f32 v18, v18, v22
    v_mul_f32 v19, v19, v22
    s_nop 3
    s_branch L_ret_m2
L_rare_m3:
    s_nop 15
    v_mov_b32 v21, v20
    s_nop 1
    v_permlane32_swap_b32 v20, v21
    v_max_f32 v20, v20, v21
    v_max_f32 v20, 0, v20
    v_exp_f32 v22, -v20
    v_sub_f32 v128, v128, v20
    v_sub_f32 v129, v129, v20
    v_sub_f32 v130, v130, v20
    v_sub_f32 v131, v131, v20
    v_sub_f32 v132, v132, v20
    v_sub_f32 v133, v133, v20
    v_sub_f32 v134, v134, v20
    v_sub_f32 v135, v135, v20
    v_sub_f32 v136, v136, v20
    v_sub_f32 v137, v137, v20
    v_sub_f32 v138, v138, v20
    v_sub_f32 v139, v139, v20
    v_sub_f32 v140, v140, v20
    v_sub_f32 v141, v141, v20
    v_sub_f32 v142, v142, v20
    v_sub_f32 v143, v143, v20
    v_sub_f32 v144, v144, v20
    v_sub_f32 v145, v145, v20
    v_sub_f32 v146, v146, v20
    v_sub_f32 v147, v147, v20
    v_sub_f32 v148, v148, v20
    v_sub_f32 v149, v149, v20
    v_sub_f32 v150, v150, v20
    v_sub_f32 v151, v151, v20
    v_sub_f32 v152, v152, v20
    v_sub_f32 v153, v153, v20
    v_sub_f32 v154, v154, v20
    v_sub_f32 v155, v155, v20
    v_sub_f32 v156, v156, v20
    v_sub_f32 v157, v157, v20
    v_sub_f32 v158, v158, v20
    v_sub_f32 v159, v159, v20
    v_sub_f32 v192, v192, v20
    v_sub_f32 v193, v193, v20
    v_sub_f32 v194, v194, v20
    v_sub_f32 v195, v195, v20
    v_sub_f32 v196, v196, v20
    v_sub_f32 v197, v197, v20
    v_sub_f32 v198, v198, v20
    v_sub_f32 v199, v199, v20
    v_sub_f32 v200, v200, v20
    v_sub_f32 v201, v201, v20
    v_sub_f32 v202, v202, v20
    v_sub_f32 v203, v203, v20
    v_sub_f32 v204, v204, v20
    v_sub_f32 v205, v205, v20
    v_sub_f32 v206, v206, v20
    v_sub_f32 v207, v207, v20
    v_mul_f32 v64, v64, v22
    v_mul_f32 v65, v65, v22
    v_mul_f32 v66, v66, v22
    v_mul_f32 v67, v67, v22
    v_mul_f32 v68, v68, v22
    v_mul_f32 v69, v69, v22
    v_mul_f32 v70, v70, v22
    v_mul_f32 v71, v71, v22
    v_mul_f32 v72, v72, v22
    v_mul_f32 v73, v73, v22
    v_mul_f32 v74, v74, v22
    v_mul_f32 v75, v75, v22
    v_mul_f32 v76, v76, v22
    v_mul_f32 v77, v77, v22
    v_mul_f32 v78, v78, v22
    v_mul_f32 v79, v79, v22
    v_mul_f32 v80, v80, v22
    v_mul_f32 v81, v81, v22
    v_mul_f32 v82, v82, v22
    v_mul_f32 v83, v83, v22
    v_mul_f32 v84, v84, v22
    v_mul_f32 v85, v85, v22
    v_mul_f32 v86, v86, v22
    v_mul_f32 v87, v87, v22
    v_mul_f32 v88, v88, v22
    v_mul_f32 v89, v89, v22
    v_mul_f32 v90, v90, v22
    v_mul_f32 v91, v91, v22
    v_mul_f32 v92, v92, v22
    v_mul_f32 v93, v93, v22
    v_mul_f32 v94, v94, v22
    v_mul_f32 v95, v95, v22
    v_mul_f32 v96, v96, v22
    v_mul_f32 v97, v97, v22
    v_mul_f32 v98, v98, v22
    v_mul_f32 v99, v99, v22
    v_mul_f32 v100, v100, v22
    v_mul_f32 v101, v101, v22
    v_mul_f32 v102, v102, v22
    v_mul_f32 v103, v103, v22
    v_mul_f32 v104, v104, v22
    v_mul_f32 v105, v105, v22
    v_mul_f32 v106, v106, v22
    v_mul_f32 v107, v107, v22
    v_mul_f32 v108, v108, v22
    v_mul_f32 v109, v109, v22
    v_mul_f32 v110, v110, v22
    v_mul_f32 v111, v111, v22
    v_mul_f32 v112, v112, v22
    v_mul_f32 v113, v113, v22
    v_mul_f32 v114, v114, v22
    v_mul_f32 v115, v115, v22
    v_mul_f32 v116, v116, v22
    v_mul_f32 v117, v117, v22
    v_mul_f32 v118, v118, v22
    v_mul_f32 v119, v119, v22
    v_mul_f32 v120, v120, v22
    v_mul_f32 v121, v121, v22
    v_mul_f32 v122, v122, v22
    v_mul_f32 v123, v123, v22
    v_mul_f32 v124, v124, v22
    v_mul_f32 v125, v125, v22
    v_mul_f32 v126, v126, v22
    v_mul_f32 v127, v127, v22
    v_mul_f32 v18, v18, v22
    v_mul_f32 v19, v19, v22
    s_nop 3
    s_branch L_ret_m3
L_rare_t28:
    s_nop 15
    v_mov_b32 v21, v20
    s_nop 1
    v_permlane32_swap_b32 v20, v21
    v_max_f32 v20, v20, v21
    v_max_f32 v20, 0, v20
    v_exp_f32 v22, -v20
    v_sub_f32 v160, v160, v20
    v_sub_f32 v161, v161, v20
    v_sub_f32 v162, v162, v20
    v_sub_f32 v163, v163, v20
    v_sub_f32 v164, v164, v20
    v_sub_f32 v165, v165, v20
    v_sub_f32 v166, v166, v20
    v_sub_f32 v167, v167, v20
    v_sub_f32 v168, v168, v20
    v_sub_f32 v169, v169, v20
    v_sub_f32 v170, v170, v20
    v_sub_f32 v171, v171, v20
    v_sub_f32 v172, v172, v20
    v_sub_f32 v173, v173, v20
    v_sub_f32 v174, v174, v20
    v_sub_f32 v175, v175, v20
    v_sub_f32 v176, v176, v20
    v_sub_f32 v177, v177, v20
    v_sub_f32 v178, v178, v20
    v_sub_f32 v179, v179, v20
    v_sub_f32 v180, v180, v20
    v_sub_f32 v181, v181, v20
    v_sub_f32 v182, v182, v20
    v_sub_f32 v183, v183, v20
    v_sub_f32 v184, v184, v20
    v_sub_f32 v185, v185, v20
    v_sub_f32 v186, v186, v20
    v_sub_f32 v187, v187, v20
    v_sub_f32 v188, v188, v20
    v_sub_f32 v189, v189, v20
    v_sub_f32 v190, v190, v20
    v_sub_f32 v191, v191, v20
    v_sub_f32 v192, v192, v20
    v_sub_f32 v193, v193, v20
    v_sub_f32 v194, v194, v20
    v_sub_f32 v195, v195, v20
    v_sub_f32 v196, v196, v20
    v_sub_f32 v197, v197, v20
    v_sub_f32 v198, v198, v20
    v_sub_f32 v199, v199, v20
    v_sub_f32 v200, v200, v20
    v_sub_f32 v201, v201, v20
    v_sub_f32 v202, v202, v20
    v_sub_f32 v203, v203, v20
    v_sub_f32 v204, v204, v20
    v_sub_f32 v205, v205, v20
    v_sub_f32 v206, v206, v20
    v_sub_f32 v207, v207, v20
    v_mul_f32 v64, v64, v22
    v_mul_f32 v65, v65, v22
    v_mul_f32 v66, v66, v22
    v_mul_f32 v67, v67, v22
    v_mul_f32 v68, v68, v22
    v_mul_f32 v69, v69, v22
    v_mul_f32 v70, v70, v22
    v_mul_f32 v71, v71, v22
    v_mul_f32 v72, v72, v22
    v_mul_f32 v73, v73, v22
    v_mul_f32 v74, v74, v22
    v_mul_f32 v75, v75, v22
    v_mul_f32 v76, v76, v22
    v_mul_f32 v77, v77, v22
    v_mul_f32 v78, v78, v22
    v_mul_f32 v79, v79, v22
    v_mul_f32 v80, v80, v22
    v_mul_f32 v81, v81, v22
    v_mul_f32 v82, v82, v22
    v_mul_f32 v83, v83, v22
    v_mul_f32 v84, v84, v22
    v_mul_f32 v85, v85, v22
    v_mul_f32 v86, v86, v22
    v_mul_f32 v87, v87, v22
    v_mul_f32 v88, v88, v22
    v_mul_f32 v89, v89, v22
    v_mul_f32 v90, v90, v22
    v_mul_f32 v91, v91, v22
    v_mul_f32 v92, v92, v22
    v_mul_f32 v93, v93, v22
    v_mul_f32 v94, v94, v22
    v_mul_f32 v95, v95, v22
    v_mul_f32 v96, v96, v22
    v_mul_f32 v97, v97, v22
    v_mul_f32 v98, v98, v22
    v_mul_f32 v99, v99, v22
    v_mul_f32 v100, v100, v22
    v_mul_f32 v101, v101, v22
    v_mul_f32 v102, v102, v22
    v_mul_f32 v103, v103, v22
    v_mul_f32 v104, v104, v22
    v_mul_f32 v105, v105, v22
    v_mul_f32 v106, v106, v22
    v_mul_f32 v107, v107, v22
    v_mul_f32 v108, v108, v22
    v_mul_f32 v109, v109, v22
    v_mul_f32 v110, v110, v22
    v_mul_f32 v111, v111, v22
    v_mul_f32 v112, v112, v22
    v_mul_f32 v113, v113, v22
    v_mul_f32 v114, v114, v22
    v_mul_f32 v115, v115, v22
    v_mul_f32 v116, v116, v22
    v_mul_f32 v117, v117, v22
    v_mul_f32 v118, v118, v22
    v_mul_f32 v119, v119, v22
    v_mul_f32 v120, v120, v22
    v_mul_f32 v121, v121, v22
    v_mul_f32 v122, v122, v22
    v_mul_f32 v123, v123, v22
    v_mul_f32 v124, v124, v22
    v_mul_f32 v125, v125, v22
    v_mul_f32 v126, v126, v22
    v_mul_f32 v127, v127, v22
    v_mul_f32 v18, v18, v22
    v_mul_f32 v19, v19, v22
    s_nop 3
    s_branch L_ret_t28
L_rare_t29:
    s_nop 15
    v_mov_b32 v21, v20
    s_nop 1
    v_permlane32_swap_b32 v20, v21
    v_max_f32 v20, v20, v21
    v_max_f32 v20, 0, v20
    v_exp_f32 v22, -v20
    v_sub_f32 v128, v128, v20
    v_sub_f32 v129, v129, v20
    v_sub_f32 v130, v130, v20
    v_sub_f32 v131, v131, v20
    v_sub_f32 v132, v132, v20
    v_sub_f32 v133, v133, v20
    v_sub_f32 v134, v134, v20
    v_sub_f32 v135, v135, v20
    v_sub_f32 v136, v136, v20
    v_sub_f32 v137, v137, v20
    v_sub_f32 v138, v138, v20
    v_sub_f32 v139, v139, v20
    v_sub_f32 v140, v140, v20
    v_sub_f32 v141, v141, v20
    v_sub_f32 v142, v142, v20
    v_sub_f32 v143, v143, v20
    v_sub_f32 v144, v144, v20
    v_sub_f32 v145, v145, v20
    v_sub_f32 v146, v146, v20
    v_sub_f32 v147, v147, v20
    v_sub_f32 v148, v148, v20
    v_sub_f32 v149, v149, v20
    v_sub_f32 v150, v150, v20
    v_sub_f32 v151, v151, v20
    v_sub_f32 v152, v152, v20
    v_sub_f32 v153, v153, v20
    v_sub_f32 v154, v154, v20
    v_sub_f32 v155, v155, v20
    v_sub_f32 v156, v156, v20
    v_sub_f32 v157, v157, v20
    v_sub_f32 v158, v158, v20
    v_sub_f32 v159, v159, v20
    v_sub_f32 v192, v192, v20
    v_sub_f32 v193, v193, v20
    v_sub_f32 v194, v194, v20
    v_sub_f32 v195, v195, v20
    v_sub_f32 v196, v196, v20
    v_sub_f32 v197, v197, v20
    v_sub_f32 v198, v198, v20
    v_sub_f32 v199, v199, v20
    v_sub_f32 v200, v200, v20
    v_sub_f32 v201, v201, v20
    v_sub_f32 v202, v202, v20
    v_sub_f32 v203, v203, v20
    v_sub_f32 v204, v204, v20
    v_sub_f32 v205, v205, v20
    v_sub_f32 v206, v206, v20
    v_sub_f32 v207, v207, v20
    v_mul_f32 v64, v64, v22
    v_mul_f32 v65, v65, v22
    v_mul_f32 v66, v66, v22
    v_mul_f32 v67, v67, v22
    v_mul_f32 v68, v68, v22
    v_mul_f32 v69, v69, v22
    v_mul_f32 v70, v70, v22
    v_mul_f32 v71, v71, v22
    v_mul_f32 v72, v72, v22
    v_mul_f32 v73, v73, v22
    v_mul_f32 v74, v74, v22
    v_mul_f32 v75, v75, v22
    v_mul_f32 v76, v76, v22
    v_mul_f32 v77, v77, v22
    v_mul_f32 v78, v78, v22
    v_mul_f32 v79, v79, v22
    v_mul_f32 v80, v80, v22
    v_mul_f32 v81, v81, v22
    v_mul_f32 v82, v82, v22
    v_mul_f32 v83, v83, v22
    v_mul_f32 v84, v84, v22
    v_mul_f32 v85, v85, v22
    v_mul_f32 v86, v86, v22
    v_mul_f32 v87, v87, v22
    v_mul_f32 v88, v88, v22
    v_mul_f32 v89, v89, v22
    v_mul_f32 v90, v90, v22
    v_mul_f32 v91, v91, v22
    v_mul_f32 v92, v92, v22
    v_mul_f32 v93, v93, v22
    v_mul_f32 v94, v94, v22
    v_mul_f32 v95, v95, v22
    v_mul_f32 v96, v96, v22
    v_mul_f32 v97, v97, v22
    v_mul_f32 v98, v98, v22
    v_mul_f32 v99, v99, v22
    v_mul_f32 v100, v100, v22
    v_mul_f32 v101, v101, v22
    v_mul_f32 v102, v102, v22
    v_mul_f32 v103, v103, v22
    v_mul_f32 v104, v104, v22
    v_mul_f32 v105, v105, v22
    v_mul_f32 v106, v106, v22
    v_mul_f32 v107, v107, v22
    v_mul_f32 v108, v108, v22
    v_mul_f32 v109, v109, v22
    v_mul_f32 v110, v110, v22
    v_mul_f32 v111, v111, v22
    v_mul_f32 v112, v112, v22
    v_mul_f32 v113, v113, v22
    v_mul_f32 v114, v114, v22
    v_mul_f32 v115, v115, v22
    v_mul_f32 v116, v116, v22
    v_mul_f32 v117, v117, v22
    v_mul_f32 v118, v118, v22
    v_mul_f32 v119, v119, v22
    v_mul_f32 v120, v120, v22
    v_mul_f32 v121, v121, v22
    v_mul_f32 v122, v122, v22
    v_mul_f32 v123, v123, v22
    v_mul_f32 v124, v124, v22
    v_mul_f32 v125, v125, v22
    v_mul_f32 v126, v126, v22
    v_mul_f32 v127, v127, v22
    v_mul_f32 v18, v18, v22
    v_mul_f32 v19, v19, v22
    s_nop 3
    s_branch L_ret_t29
L_rare_t30:
    s_nop 15
    v_mov_b32 v21, v20
    s_nop 1
    v_permlane32_swap_b32 v20, v21
    v_max_f32 v20, v20, v21
    v_max_f32 v20, 0, v20
    v_exp_f32 v22, -v20
    v_sub_f32 v160, v160, v20
    v_sub_f32 v161, v161, v20
    v_sub_f32 v162, v162, v20
    v_sub_f32 v163, v163, v20
    v_sub_f32 v164, v164, v20
    v_sub_f32 v165, v165, v20
    v_sub_f32 v166, v166, v20
    v_sub_f32 v167, v167, v20
    v_sub_f32 v168, v168, v20
    v_sub_f32 v169, v169, v20
    v_sub_f32 v170, v170, v20
    v_sub_f32 v171, v171, v20
    v_sub_f32 v172, v172, v20
    v_sub_f32 v173, v173, v20
    v_sub_f32 v174, v174, v20
    v_sub_f32 v175, v175, v20
    v_sub_f32 v176, v176, v20
    v_sub_f32 v177, v177, v20
    v_sub_f32 v178, v178, v20
    v_sub_f32 v179, v179, v20
    v_sub_f32 v180, v180, v20
    v_sub_f32 v181, v181, v20
    v_sub_f32 v182, v182, v20
    v_sub_f32 v183, v183, v20
    v_sub_f32 v184, v184, v20
    v_sub_f32 v185, v185, v20
    v_sub_f32 v186, v186, v20
    v_sub_f32 v187, v187, v20
    v_sub_f32 v188, v188, v20
    v_sub_f32 v189, v189, v20
    v_sub_f32 v190, v190, v20
    v_sub_f32 v191, v191, v20
    v_sub_f32 v192, v192, v20
    v_sub_f32 v193, v193, v20
    v_sub_f32 v194, v194, v20
    v_sub_f32 v195, v195, v20
    v_sub_f32 v196, v196, v20
    v_sub_f32 v197, v197, v20
    v_sub_f32 v198, v198, v20
    v_sub_f32 v199, v199, v20
    v_sub_f32 v200, v200, v20
    v_sub_f32 v201, v201, v20
    v_sub_f32 v202, v202, v20
    v_sub_f32 v203, v203, v20
    v_sub_f32 v204, v204, v20
    v_sub_f32 v205, v205, v20
    v_sub_f32 v206, v206, v20
    v_sub_f32 v207, v207, v20
    v_mul_f32 v64, v64, v22
    v_mul_f32 v65, v65, v22
    v_mul_f32 v66, v66, v22
    v_mul_f32 v67, v67, v22
    v_mul_f32 v68, v68, v22
    v_mul_f32 v69, v69, v22
    v_mul_f32 v70, v70, v22
    v_mul_f32 v71, v71, v22
    v_mul_f32 v72, v72, v22
    v_mul_f32 v73, v73, v22
    v_mul_f32 v74, v74, v22
    v_mul_f32 v75, v75, v22
    v_mul_f32 v76, v76, v22
    v_mul_f32 v77, v77, v22
    v_mul_f32 v78, v78, v22
    v_mul_f32 v79, v79, v22
    v_mul_f32 v80, v80, v22
    v_mul_f32 v81, v81, v22
    v_mul_f32 v82, v82, v22
    v_mul_f32 v83, v83, v22
    v_mul_f32 v84, v84, v22
    v_mul_f32 v85, v85, v22
    v_mul_f32 v86, v86, v22
    v_mul_f32 v87, v87, v22
    v_mul_f32 v88, v88, v22
    v_mul_f32 v89, v89, v22
    v_mul_f32 v90, v90, v22
    v_mul_f32 v91, v91, v22
    v_mul_f32 v92, v92, v22
    v_mul_f32 v93, v93, v22
    v_mul_f32 v94, v94, v22
    v_mul_f32 v95, v95, v22
    v_mul_f32 v96, v96, v22
    v_mul_f32 v97, v97, v22
    v_mul_f32 v98, v98, v22
    v_mul_f32 v99, v99, v22
    v_mul_f32 v100, v100, v22
    v_mul_f32 v101, v101, v22
    v_mul_f32 v102, v102, v22
    v_mul_f32 v103, v103, v22
    v_mul_f32 v104, v104, v22
    v_mul_f32 v105, v105, v22
    v_mul_f32 v106, v106, v22
    v_mul_f32 v107, v107, v22
    v_mul_f32 v108, v108, v22
    v_mul_f32 v109, v109, v22
    v_mul_f32 v110, v110, v22
    v_mul_f32 v111, v111, v22
    v_mul_f32 v112, v112, v22
    v_mul_f32 v113, v113, v22
    v_mul_f32 v114, v114, v22
    v_mul_f32 v115, v115, v22
    v_mul_f32 v116, v116, v22
    v_mul_f32 v117, v117, v22
    v_mul_f32 v118, v118, v22
    v_mul_f32 v119, v119, v22
    v_mul_f32 v120, v120, v22
    v_mul_f32 v121, v121, v22
    v_mul_f32 v122, v122, v22
    v_mul_f32 v123, v123, v22
    v_mul_f32 v124, v124, v22
    v_mul_f32 v125, v125, v22
    v_mul_f32 v126, v126, v22
    v_mul_f32 v127, v127, v22
    v_mul_f32 v18, v18, v22
    v_mul_f32 v19, v19, v22
    s_nop 3
    s_branch L_ret_t30
L_cnt:
    s_sleep 8
    v_mov_b32 v26, 0
    buffer_load_dword v26, v26, s[80:83], 0 offen sc1
    s_waitcnt vmcnt(0)
    v_readfirstlane_b32 s47, v26
    s_cmp_ge_u32 s47, 256
    s_cbranch_scc1 L_cnt_ok
    s_sub_u32 s56, s56, 1
    s_cmp_lg_u32 s56, 0
    s_cbranch_scc1 L_cnt
    s_branch L_done
L_wrd_0:
    ds_read_b128 a[0:3], v24 offset:0
    ds_read_b128 a[4:7], v24 offset:1024
    ds_read_b128 a[8:11], v24 offset:2048
    ds_read_b128 a[12:15], v24 offset:3072
    ds_read_b128 a[16:19], v24 offset:4096
    ds_read_b128 a[20:23], v24 offset:5120
    ds_read_b128 a[24:27], v24 offset:6144
    ds_read_b128 a[28:31], v24 offset:7168
    s_branch L_wrd_ret
L_wrd_1:
    ds_read_b128 a[32:35], v24 offset:0
    ds_read_b128 a[36:39], v24 offset:1024
    ds_read_b128 a[40:43], v24 offset:2048
    ds_read_b128 a[44:47], v24 offset:3072
    ds_read_b128 a[48:51], v24 offset:4096
    ds_read_b128 a[52:55], v24 offset:5120
    ds_read_b128 a[56:59], v24 offset:6144
    ds_read_b128 a[60:63], v24 offset:7168
    s_branch L_wrd_ret
L_wrd_2:
    ds_read_b128 a[64:67], v24 offset:0
    ds_read_b128 a[68:71], v24 offset:1024
    ds_read_b128 a[72:75], v24 offset:2048
    ds_read_b128 a[76:79], v24 offset:3072
    ds_read_b128 a[80:83], v24 offset:4096
    ds_read_b128 a[84:87], v24 offset:5120
    ds_read_b128 a[88:91], v24 offset:6144
    ds_read_b128 a[92:95], v24 offset:7168
    s_branch L_wrd_ret
L_wrd_3:
    ds_read_b128 a[96:99], v24 offset:0
    ds_read_b128 a[100:103], v24 offset:1024
    ds_read_b128 a[104:107], v24 offset:2048
    ds_read_b128 a[108:111], v24 offset:3072
    ds_read_b128 a[112:115], v24 offset:4096
    ds_read_b128 a[116:119], v24 offset:5120
    ds_read_b128 a[120:123], v24 offset:6144
    ds_read_b128 a[124:127], v24 offset:7168
    s_branch L_wrd_ret
L_wrd_4:
    ds_read_b128 a[128:131], v24 offset:0
    ds_read_b128 a[132:135], v24 offset:1024
    ds_read_b128 a[136:139], v24 offset:2048
    ds_read_b128 a[140:143], v24 offset:3072
    ds_read_b128 a[144:147], v24 offset:4096
    ds_read_b128 a[148:151], v24 offset:5120
    ds_read_b128 a[152:155], v24 offset:6144
    ds_read_b128 a[156:159], v24 offset:7168
    s_branch L_wrd_ret
L_wrd_5:
    ds_read_b128 a[160:163], v24 offset:0
    ds_read_b128 a[164:167], v24 offset:1024
    ds_read_b128 a[168:171], v24 offset:2048
    ds_read_b128 a[172:175], v24 offset:3072
    ds_read_b128 a[176:179], v24 offset:4096
    ds_read_b128 a[180:183], v24 offset:5120
    ds_read_b128 a[184:187], v24 offset:6144
    ds_read_b128 a[188:191], v24 offset:7168
    s_branch L_wrd_ret
.section .rodata,"a"
.p2align 6
.amdhsa_kernel standalone__mha_block_cached__near_ridge_kernel
  .amdhsa_next_free_vgpr 512
  .amdhsa_next_free_sgpr 100
  .amdhsa_accum_offset 256
  .amdhsa_group_segment_fixed_size 0
  .amdhsa_kernarg_size 64
  .amdhsa_user_sgpr_count 2
  .amdhsa_user_sgpr_kernarg_segment_ptr 1
  .amdhsa_system_sgpr_workgroup_id_x 1
.end_amdhsa_kernel
```
